```python
import torch

def _softmax(x, axis=-1):
    return torch.softmax(x, dim=axis)
def _gelu(x):
    return torch.nn.functional.gelu(x, approximate="tanh")
def _silu(x):
    return torch.nn.functional.silu(x)
def _sigmoid(x):
    return torch.sigmoid(x)
def _layernorm(x, axis=-1, eps=1e-5):
    m = x.mean(dim=axis, keepdim=True)
    v = x.var(dim=axis, keepdim=True, unbiased=False)
    return (x - m) / torch.sqrt(v + eps)
def _scatter_add(tgt, idx, src, axis=0):
    return tgt.clone().index_add_(axis, idx, src)
def _segment_sum(src, seg, n):
    out = torch.zeros((n,) + src.shape[1:], dtype=src.dtype)
    return out.index_add_(0, seg, src)
def _pad(x, pw):
    flat = tuple(v for pair in reversed(pw) for v in pair)
    return torch.nn.functional.pad(x, flat)

kernel_name = 'recurrent_scan__spectral_fnet__dense_activation_squared_relu__prompt'

def setup_inputs():

    _w = (lambda a: (lambda t: t.to(torch.bfloat16) if t.is_floating_point() else t)(torch.as_tensor(a)))
    def _A_setup():
        B, S, D = 1, 2048, 512
        ns = torch.arange(S)[:, None] * torch.arange(S)[None, :]
        nd = torch.arange(D)[:, None] * torch.arange(D)[None, :]
        Ws_re = torch.cos(-2.0 * torch.pi * ns / S).to(float)
        Ws_im = torch.sin(-2.0 * torch.pi * ns / S).to(float)
        Wd_re = torch.cos(-2.0 * torch.pi * nd / D).to(float)
        Wd_im = torch.sin(-2.0 * torch.pi * nd / D).to(float)
        return {
            "x": _w((lambda *s: torch.randn(*s, dtype=torch.bfloat16) * 0.05)(B, S, D)),
            "dft_seq_re": _w(Ws_re),
            "dft_seq_im": _w(Ws_im),
            "dft_hid_re": _w(Wd_re),
            "dft_hid_im": _w(Wd_im),
        }
    _A_in = _A_setup()

    def _B_setup():
        B, S, D, F = 1, 2048, 512, 1792
        return {
            "x": _w((lambda *s: torch.randn(*s, dtype=torch.bfloat16) * 0.05)(B, S, D)),
            "w1": _w((lambda *s: torch.randn(*s, dtype=torch.bfloat16) * 0.05)(D, F)),
            "b1": _w((lambda *s: torch.randn(*s, dtype=torch.bfloat16) * 0.4)(F)),
            "w2": _w((lambda *s: torch.randn(*s, dtype=torch.bfloat16) * 0.05)(F, D)),
            "b2": _w((lambda *s: torch.randn(*s, dtype=torch.bfloat16) * 0.8)(D)),
        }
    _B_in = _B_setup()

    return {
        "A_x": _A_in["x"],
        "A_dft_seq_re": _A_in["dft_seq_re"],
        "A_dft_seq_im": _A_in["dft_seq_im"],
        "A_dft_hid_re": _A_in["dft_hid_re"],
        "A_dft_hid_im": _A_in["dft_hid_im"],
        "B_x": _B_in["x"],
        "B_w1": _B_in["w1"],
        "B_b1": _B_in["b1"],
        "B_w2": _B_in["w2"],
        "B_b2": _B_in["b2"],
    }

def reference(A_x, A_dft_seq_re, A_dft_seq_im, A_dft_hid_re, A_dft_hid_im, B_x, B_w1, B_b1, B_w2, B_b2):
    def _A_ref(x, dft_seq_re, dft_seq_im, dft_hid_re, dft_hid_im):
        a = torch.einsum("bsd,ed->bse", x, dft_hid_re)
        b = torch.einsum("bsd,ed->bse", x, dft_hid_im)
        y = torch.einsum("ts,bse->bte", dft_seq_re, a) - torch.einsum("ts,bse->bte", dft_seq_im, b)
        return y

    def _B_ref(x, w1, b1, w2, b2):
        h = torch.einsum("bsd,df->bsf", x, w1) + b1
        zero = torch.zeros_like(h)
        r = torch.where(h > zero, h, zero)
        h = r * r
        out = torch.einsum("bsf,fd->bsd", h, w2) + b2
        return out

    x = A_x
    xn = _layernorm(x, axis=-1)
    s = _A_ref(xn, A_dft_seq_re, A_dft_seq_im, A_dft_hid_re, A_dft_hid_im)
    g = _silu(_B_ref(xn, B_w1, B_b1, B_w2, B_b2))
    return x + s * g
```

```asm
; @launch kernel=k1_kernel grid=(256,1,1) block=(512,1,1) lds=158208
; @launch kernel=k2_kernel grid=(256,1,1) block=(256,1,1) lds=66368
.amdgcn_target "amdgcn-amd-amdhsa--gfx950"
.text
.globl k1_kernel
.p2align 8
.type k1_kernel,@function
k1_kernel:
    s_cmp_ge_u32 s2, 256
    s_cbranch_scc1 K1_END
    s_load_dwordx16 s[4:19], s[0:1], 0
    s_load_dwordx8 s[20:27], s[0:1], 64
    s_load_dwordx2 s[28:29], s[0:1], 96
    s_and_b32 s78, s2, 1
    s_and_b32 s52, s2, 6
    s_bfe_u32 s55, s2, 0x10003
    s_add_u32 s52, s52, s55
    s_lshr_b32 s53, s2, 4
    s_lshl_b32 s73, s52, 1
    s_add_u32 s73, s73, s78
    s_add_u32 s73, s73, s53
    s_add_u32 s73, s52, s53
    s_and_b32 s73, s73, 3
    s_lshl_b32 s73, s73, 1
    v_lshrrev_b32 v1, 6, v0
    v_and_b32 v2, 15, v0
    v_readfirstlane_b32 s54, v1
    v_and_b32 v1, 63, v0
    s_getpc_b64 s[30:31]
K1_PC:
    v_lshlrev_b32 v16, 7, v0
    v_min_u32 v17, CODE_END-K1_PC-4, v16
    global_load_dword v0, v17, s[30:31]
    v_lshrrev_b32 v3, 4, v1
    s_and_b32 s55, s54, 3
    s_lshl_b32 s62, s55, 12
    s_cmp_lt_u32 s54, 4
    s_cbranch_scc1 K1_CONS
    s_setprio 3
    s_lshl_b32 s56, s52, 6
    s_add_u32 s56, s56, s78
    s_lshl_b32 s57, s55, 4
    s_add_u32 s56, s56, s57
    v_bfe_u32 v36, v1, 3, 2
    v_mov_b32 v37, 0x400
    v_cmp_eq_u32 vcc, 0, v36
    v_add_u32 v40, 1, v36
    v_and_b32 v40, 2, v40
    v_cndmask_b32 v37, v37, 0, vcc
    v_sub_u32 v38, 1, v40
    v_cmp_eq_u32 vcc, 1, v36
    v_mov_b32 v40, 0x800
    v_and_b32 v39, 1, v36
    v_cndmask_b32 v37, v37, v40, vcc
    v_lshlrev_b32 v39, 10, v39
    v_lshrrev_b32 v40, 1, v36
    v_lshl_add_u32 v39, v40, 9, v39
    v_lshrrev_b32 v40, 5, v1
    v_lshl_add_u32 v40, v40, 1, s56
    v_and_b32 v41, 7, v1
    v_xor_b32 v41, v41, v3
    v_lshlrev_b32 v41, 4, v41
    v_xor_b32 v42, 64, v41
    v_mad_i32_i24 v43, v38, v40, v37
    v_cmp_eq_u32 vcc, 0, v40
    s_nop 1
    v_cndmask_b32 v43, v43, v39, vcc
    v_lshl_add_u32 v224, v43, 10, v41
    v_add_u32 v40, 4, v40
    v_mad_i32_i24 v43, v38, v40, v37
    v_lshl_add_u32 v225, v43, 10, v42
    v_add_u32 v40, 4, v40
    v_mad_i32_i24 v43, v38, v40, v37
    v_lshl_add_u32 v226, v43, 10, v41
    v_add_u32 v40, 4, v40
    v_mad_i32_i24 v43, v38, v40, v37
    v_lshl_add_u32 v227, v43, 10, v42
    v_and_b32 v36, 7, v1
    v_and_b32 v37, 1, v3
    v_lshlrev_b32 v37, 1, v37
    v_xor_b32 v36, v36, v37
    v_lshlrev_b32 v36, 4, v36
    v_xor_b32 v37, 64, v36
    v_lshrrev_b32 v38, 3, v1
    s_lshl_b32 s57, s55, 11
    s_lshl_b32 s72, s73, 7
    s_waitcnt lgkmcnt(0)
    s_mov_b32 s32, s4
    s_and_b32 s33, s5, 0xffff
    s_mov_b32 s34, 0x200000
    s_mov_b32 s35, 0x00020000
    s_cmp_lt_u32 s53, 14
    s_cbranch_scc0 K1_H_DSRC
    s_mov_b32 s44, s16
    s_and_b32 s45, s17, 0xffff
    s_mov_b32 s46, 0x1c0000
    s_mov_b32 s47, 0x00020000
    s_mov_b32 s58, 3584
    s_lshl_b32 s59, s53, 8
    s_branch K1_H_SRC
K1_H_DSRC:
    s_mov_b32 s44, s10
    s_and_b32 s45, s11, 0xffff
    s_mov_b32 s46, 0x80000
    s_mov_b32 s47, 0x00020000
    s_mov_b32 s58, 1024
    s_sub_u32 s59, s53, 14
    s_lshl_b32 s59, s59, 8
K1_H_SRC:
    v_mad_u32_u24 v228, v38, s58, v36
    v_mad_u32_u24 v229, v38, s58, v37
    s_lshl_b32 s60, s55, 4
    s_mul_i32 s60, s60, s58
    s_add_u32 s60, s60, s59
    s_add_u32 s61, s60, 128
    s_lshl_b32 s63, s58, 3
    s_lshr_b32 s59, s58, 1
    s_add_u32 s74, s72, 0
    s_and_b32 s74, s74, 1023
    s_add_u32 m0, s62, 8192
    s_mul_i32 s75, s74, s59
    buffer_load_dwordx4 v224, s[32:35], s74 offen lds
    s_add_u32 m0, s62, 9216
    s_add_u32 s75, s75, s60
    buffer_load_dwordx4 v225, s[32:35], s74 offen lds
    s_add_u32 m0, s57, 0
    s_nop 0
    buffer_load_dwordx4 v228, s[44:47], s75 offen lds
    s_add_u32 m0, s62, 10240
    s_nop 0
    buffer_load_dwordx4 v226, s[32:35], s74 offen lds
    s_add_u32 m0, s62, 11264
    s_nop 0
    buffer_load_dwordx4 v227, s[32:35], s74 offen lds
    s_add_u32 m0, s57, 1024
    s_add_u32 s75, s75, s63
    buffer_load_dwordx4 v229, s[44:47], s75 offen lds
    s_mov_b32 s40, s18
    s_and_b32 s41, s19, 0xffff
    s_mov_b32 s42, 0xe00
    s_mov_b32 s43, 0x00020000
    v_lshlrev_b32 v39, 2, v1
    s_lshl_b32 s71, s53, 8
    buffer_load_dword v46, v39, s[40:43], s71 offen
    s_add_u32 s74, s72, 128
    s_and_b32 s74, s74, 1023
    s_add_u32 m0, s62, 32768
    s_mul_i32 s75, s74, s59
    buffer_load_dwordx4 v224, s[32:35], s74 offen lds
    s_add_u32 m0, s62, 33792
    s_add_u32 s75, s75, s60
    buffer_load_dwordx4 v225, s[32:35], s74 offen lds
    s_add_u32 m0, s57, 24576
    s_nop 0
    buffer_load_dwordx4 v228, s[44:47], s75 offen lds
    s_add_u32 m0, s62, 34816
    s_nop 0
    buffer_load_dwordx4 v226, s[32:35], s74 offen lds
    s_add_u32 m0, s62, 35840
    s_nop 0
    buffer_load_dwordx4 v227, s[32:35], s74 offen lds
    s_add_u32 m0, s57, 25600
    s_add_u32 s75, s75, s63
    buffer_load_dwordx4 v229, s[44:47], s75 offen lds
    s_add_u32 s74, s72, 256
    s_and_b32 s74, s74, 1023
    s_add_u32 m0, s62, 57344
    s_mul_i32 s75, s74, s59
    buffer_load_dwordx4 v224, s[32:35], s74 offen lds
    s_add_u32 m0, s62, 58368
    s_add_u32 s75, s75, s60
    buffer_load_dwordx4 v225, s[32:35], s74 offen lds
    s_add_u32 m0, s57, 49152
    s_nop 0
    buffer_load_dwordx4 v228, s[44:47], s75 offen lds
    s_add_u32 m0, s62, 59392
    s_nop 0
    buffer_load_dwordx4 v226, s[32:35], s74 offen lds
    s_add_u32 m0, s62, 60416
    s_nop 0
    buffer_load_dwordx4 v227, s[32:35], s74 offen lds
    s_add_u32 m0, s57, 50176
    s_add_u32 s75, s75, s63
    buffer_load_dwordx4 v229, s[44:47], s75 offen lds
    s_mov_b32 s36, s28
    s_and_b32 s37, s29, 0xffff
    s_mov_b32 s38, 0xb12000
    s_mov_b32 s39, 0x00020000
    s_mov_b32 s48, s20
    s_and_b32 s49, s21, 0xffff
    s_mov_b32 s50, 0x1c0000
    s_mov_b32 s51, 0x00020000
    s_min_u32 s65, s2, 223
    s_lshr_b32 s66, s65, 3
    s_lshl_b32 s66, s66, 1
    s_lshr_b32 s67, s55, 1
    s_add_u32 s66, s66, s67
    s_and_b32 s67, s65, 7
    s_lshl_b32 s67, s67, 1
    s_and_b32 s65, s55, 1
    s_add_u32 s67, s67, s65
    s_lshl_b32 s67, s67, 1
    s_mul_i32 s71, s67, 58368
    s_lshl_b32 s65, s66, 10
    s_add_u32 s71, s71, s65
    s_add_u32 s71, s71, 0x800000
    s_lshl_b32 s68, s66, 15
    s_lshl_b32 s69, s67, 5
    s_add_u32 s68, s68, s69
    v_and_b32 v37, 3, v1
    v_lshlrev_b32 v37, 4, v37
    v_lshrrev_b32 v38, 2, v1
    v_lshl_add_u32 v230, v38, 10, v37
    v_and_b32 v37, 3, v2
    v_lshrrev_b32 v38, 2, v2
    v_lshl_add_u32 v38, v3, 2, v38
    v_lshlrev_b32 v38, 6, v38
    v_lshl_add_u32 v38, v37, 3, v38
    s_add_u32 s64, s57, 147456
    v_add_u32 v231, s64, v38
    v_mov_b32 v240, 0x3f803f80
    v_mov_b32 v241, 0x3f803f80
    v_mov_b32 v242, 0x3f803f80
    v_mov_b32 v243, 0x3f803f80
    v_lshlrev_b32 v41, 3, v1
    v_add_u32 v41, 155648, v41
    v_lshrrev_b32 v16, 1, v2
    v_xor_b32 v16, v16, v3
    v_lshlrev_b32 v16, 4, v16
    v_lshl_add_u32 v16, v2, 7, v16
    v_add_u32 v8, s62, v16
    v_add_u32 v8, 0x2000, v8
    s_and_b32 s64, s55, 1
    s_lshl_b32 s64, s64, 6
    v_xor_b32 v8, s64, v8
    v_xor_b32 v9, 64, v8
    v_lshrrev_b32 v16, 2, v2
    v_and_b32 v17, 1, v3
    v_lshrrev_b32 v18, 1, v16
    v_lshl_add_u32 v18, v17, 1, v18
    v_lshl_add_u32 v16, v3, 3, v16
    v_lshlrev_b32 v16, 7, v16
    v_lshl_add_u32 v16, v18, 5, v16
    v_and_b32 v17, 3, v2
    v_lshl_add_u32 v16, v17, 3, v16
    v_add_u32 v16, 122880, v16
    s_and_b32 s64, s55, 1
    s_lshl_b32 s64, s64, 12
    s_and_b32 s79, s55, 2
    s_lshl_b32 s79, s79, 5
    s_or_b32 s64, s64, s79
    s_lshl_b32 s79, s79, 1
    v_xor_b32 v16, s64, v16
    v_xor_b32 v4, 0, v16
    v_xor_b32 v5, 32, v16
    v_xor_b32 v6, 64, v16
    v_xor_b32 v7, 96, v16
    v_lshlrev_b32 v11, 4, v1
    v_lshlrev_b32 v12, 4, v3
    v_add_u32 v12, 155648, v12
    s_waitcnt vmcnt(12)
    v_lshlrev_b32 v42, 16, v46
    v_and_b32 v43, 0xffff0000, v46
    ds_write_b64 v41, v[42:43] offset:1536
    v_mov_b32 v44, 0
    v_mov_b32 v45, 0
    ds_write_b64 v41, v[44:45]
    ds_write_b64 v41, v[44:45] offset:2048
    s_barrier
    s_add_u32 s74, s72, 384
    s_and_b32 s74, s74, 1023
    s_add_u32 m0, s62, 81920
    s_mul_i32 s75, s74, s59
    buffer_load_dwordx4 v224, s[32:35], s74 offen lds
    ds_read_b128 v[56:59], v8 offset:0
    ds_read_b128 v[60:63], v8 offset:2048
    ds_read_b128 v[64:67], v9 offset:0
    ds_read_b128 v[68:71], v9 offset:2048
    s_add_u32 m0, s62, 82944
    s_add_u32 s75, s75, s60
    buffer_load_dwordx4 v225, s[32:35], s74 offen lds
    s_add_u32 m0, s57, 73728
    s_nop 0
    buffer_load_dwordx4 v228, s[44:47], s75 offen lds
    s_add_u32 m0, s62, 83968
    s_nop 0
    buffer_load_dwordx4 v226, s[32:35], s74 offen lds
    s_add_u32 m0, s62, 84992
    s_nop 0
    buffer_load_dwordx4 v227, s[32:35], s74 offen lds
    s_add_u32 m0, s57, 74752
    s_add_u32 s75, s75, s63
    buffer_load_dwordx4 v229, s[44:47], s75 offen lds
    s_add_u32 s74, s72, 512
    s_and_b32 s74, s74, 1023
    s_add_u32 m0, s62, 106496
    s_mul_i32 s75, s74, s59
    buffer_load_dwordx4 v224, s[32:35], s74 offen lds
    s_add_u32 m0, s62, 107520
    s_add_u32 s75, s75, s60
    buffer_load_dwordx4 v225, s[32:35], s74 offen lds
    s_add_u32 m0, s57, 98304
    s_nop 0
    buffer_load_dwordx4 v228, s[44:47], s75 offen lds
    s_add_u32 m0, s62, 108544
    s_nop 0
    buffer_load_dwordx4 v226, s[32:35], s74 offen lds
    s_add_u32 m0, s62, 109568
    s_nop 0
    buffer_load_dwordx4 v227, s[32:35], s74 offen lds
    s_add_u32 m0, s57, 99328
    s_add_u32 s75, s75, s63
    buffer_load_dwordx4 v229, s[44:47], s75 offen lds
    s_waitcnt lgkmcnt(0)
    v_mfma_f32_16x16x32_bf16 v[184:187], v[240:243], v[56:59], 0
    v_mfma_f32_16x16x32_bf16 v[192:195], v[56:59], v[56:59], 0
    v_mfma_f32_16x16x32_bf16 v[188:191], v[240:243], v[60:63], 0
    v_mfma_f32_16x16x32_bf16 v[196:199], v[60:63], v[60:63], 0
    v_mfma_f32_16x16x32_bf16 v[184:187], v[240:243], v[64:67], v[184:187]
    v_mfma_f32_16x16x32_bf16 v[192:195], v[64:67], v[64:67], v[192:195]
    v_mfma_f32_16x16x32_bf16 v[188:191], v[240:243], v[68:71], v[188:191]
    v_mfma_f32_16x16x32_bf16 v[196:199], v[68:71], v[68:71], v[196:199]
    s_waitcnt vmcnt(18)
    s_barrier
    s_add_u32 m0, s57, 147456
    s_add_u32 s70, s68, 16384
    buffer_load_dwordx4 v230, s[48:51], s68 offen lds
    ds_read_b128 v[72:75], v8 offset:24576
    ds_read_b128 v[76:79], v8 offset:26624
    ds_read_b128 v[80:83], v9 offset:24576
    ds_read_b128 v[84:87], v9 offset:26624
    s_add_u32 m0, s57, 148480
    s_nop 0
    buffer_load_dwordx4 v230, s[48:51], s70 offen lds
    s_waitcnt lgkmcnt(0)
    v_mfma_f32_16x16x32_bf16 v[184:187], v[240:243], v[72:75], v[184:187]
    v_mfma_f32_16x16x32_bf16 v[192:195], v[72:75], v[72:75], v[192:195]
    v_mfma_f32_16x16x32_bf16 v[188:191], v[240:243], v[76:79], v[188:191]
    v_mfma_f32_16x16x32_bf16 v[196:199], v[76:79], v[76:79], v[196:199]
    v_mfma_f32_16x16x32_bf16 v[184:187], v[240:243], v[80:83], v[184:187]
    v_mfma_f32_16x16x32_bf16 v[192:195], v[80:83], v[80:83], v[192:195]
    v_mfma_f32_16x16x32_bf16 v[188:191], v[240:243], v[84:87], v[188:191]
    v_mfma_f32_16x16x32_bf16 v[196:199], v[84:87], v[84:87], v[196:199]
    s_waitcnt vmcnt(14)
    s_barrier
    s_add_u32 s74, s72, 640
    s_and_b32 s74, s74, 1023
    s_add_u32 m0, s62, 8192
    s_mul_i32 s75, s74, s59
    buffer_load_dwordx4 v224, s[32:35], s74 offen lds
    ds_read_b128 v[88:91], v8 offset:49152
    ds_read_b128 v[92:95], v8 offset:51200
    ds_read_b128 v[96:99], v9 offset:49152
    ds_read_b128 v[100:103], v9 offset:51200
    s_add_u32 m0, s62, 9216
    s_add_u32 s75, s75, s60
    buffer_load_dwordx4 v225, s[32:35], s74 offen lds
    s_add_u32 m0, s57, 0
    s_nop 0
    buffer_load_dwordx4 v228, s[44:47], s75 offen lds
    s_add_u32 m0, s62, 10240
    s_nop 0
    buffer_load_dwordx4 v226, s[32:35], s74 offen lds
    s_add_u32 m0, s62, 11264
    s_nop 0
    buffer_load_dwordx4 v227, s[32:35], s74 offen lds
    s_add_u32 m0, s57, 1024
    s_add_u32 s75, s75, s63
    buffer_load_dwordx4 v229, s[44:47], s75 offen lds
    s_waitcnt lgkmcnt(0)
    v_mfma_f32_16x16x32_bf16 v[184:187], v[240:243], v[88:91], v[184:187]
    v_mfma_f32_16x16x32_bf16 v[192:195], v[88:91], v[88:91], v[192:195]
    v_mfma_f32_16x16x32_bf16 v[188:191], v[240:243], v[92:95], v[188:191]
    v_mfma_f32_16x16x32_bf16 v[196:199], v[92:95], v[92:95], v[196:199]
    v_mfma_f32_16x16x32_bf16 v[184:187], v[240:243], v[96:99], v[184:187]
    v_mfma_f32_16x16x32_bf16 v[192:195], v[96:99], v[96:99], v[192:195]
    v_mfma_f32_16x16x32_bf16 v[188:191], v[240:243], v[100:103], v[188:191]
    v_mfma_f32_16x16x32_bf16 v[196:199], v[100:103], v[100:103], v[196:199]
    v_add_u32 v8, 73728, v8
    v_add_u32 v9, 73728, v9
    s_waitcnt vmcnt(14)
    s_barrier
    s_add_u32 s74, s72, 768
    s_and_b32 s74, s74, 1023
    s_add_u32 m0, s62, 32768
    s_mul_i32 s75, s74, s59
    buffer_load_dwordx4 v224, s[32:35], s74 offen lds
    ds_read_b128 v[104:107], v8 offset:0
    ds_read_b128 v[108:111], v8 offset:2048
    ds_read_b128 v[112:115], v9 offset:0
    ds_read_b128 v[116:119], v9 offset:2048
    s_add_u32 m0, s62, 33792
    s_add_u32 s75, s75, s60
    buffer_load_dwordx4 v225, s[32:35], s74 offen lds
    s_add_u32 m0, s57, 24576
    s_nop 0
    buffer_load_dwordx4 v228, s[44:47], s75 offen lds
    s_add_u32 m0, s62, 34816
    s_nop 0
    buffer_load_dwordx4 v226, s[32:35], s74 offen lds
    s_add_u32 m0, s62, 35840
    s_nop 0
    buffer_load_dwordx4 v227, s[32:35], s74 offen lds
    s_add_u32 m0, s57, 25600
    s_add_u32 s75, s75, s63
    buffer_load_dwordx4 v229, s[44:47], s75 offen lds
    s_waitcnt lgkmcnt(0)
    v_mfma_f32_16x16x32_bf16 v[184:187], v[240:243], v[104:107], v[184:187]
    v_mfma_f32_16x16x32_bf16 v[192:195], v[104:107], v[104:107], v[192:195]
    v_mfma_f32_16x16x32_bf16 v[188:191], v[240:243], v[108:111], v[188:191]
    v_mfma_f32_16x16x32_bf16 v[196:199], v[108:111], v[108:111], v[196:199]
    v_mfma_f32_16x16x32_bf16 v[184:187], v[240:243], v[112:115], v[184:187]
    v_mfma_f32_16x16x32_bf16 v[192:195], v[112:115], v[112:115], v[192:195]
    v_mfma_f32_16x16x32_bf16 v[188:191], v[240:243], v[116:119], v[188:191]
    v_mfma_f32_16x16x32_bf16 v[196:199], v[116:119], v[116:119], v[196:199]
    s_waitcnt vmcnt(14)
    s_barrier
    s_add_u32 s74, s72, 896
    s_and_b32 s74, s74, 1023
    s_add_u32 m0, s62, 57344
    s_mul_i32 s75, s74, s59
    buffer_load_dwordx4 v224, s[32:35], s74 offen lds
    ds_read_b128 v[120:123], v8 offset:24576
    ds_read_b128 v[124:127], v8 offset:26624
    ds_read_b128 v[128:131], v9 offset:24576
    ds_read_b128 v[132:135], v9 offset:26624
    s_add_u32 m0, s62, 58368
    s_add_u32 s75, s75, s60
    buffer_load_dwordx4 v225, s[32:35], s74 offen lds
    s_add_u32 m0, s57, 49152
    s_nop 0
    buffer_load_dwordx4 v228, s[44:47], s75 offen lds
    s_add_u32 m0, s62, 59392
    s_nop 0
    buffer_load_dwordx4 v226, s[32:35], s74 offen lds
    s_add_u32 m0, s62, 60416
    s_nop 0
    buffer_load_dwordx4 v227, s[32:35], s74 offen lds
    s_add_u32 m0, s57, 50176
    s_add_u32 s75, s75, s63
    buffer_load_dwordx4 v229, s[44:47], s75 offen lds
    s_add_u32 s75, s72, 0
    s_and_b32 s75, s75, 1023
    s_mul_i32 s75, s75, s59
    s_add_u32 m0, s57, 122880
    s_add_u32 s75, s75, s61
    buffer_load_dwordx4 v228, s[44:47], s75 offen lds
    s_add_u32 m0, s57, 123904
    s_add_u32 s75, s75, s63
    buffer_load_dwordx4 v229, s[44:47], s75 offen lds
    s_waitcnt lgkmcnt(0)
    v_mfma_f32_16x16x32_bf16 v[184:187], v[240:243], v[120:123], v[184:187]
    v_mfma_f32_16x16x32_bf16 v[192:195], v[120:123], v[120:123], v[192:195]
    v_mfma_f32_16x16x32_bf16 v[188:191], v[240:243], v[124:127], v[188:191]
    v_mfma_f32_16x16x32_bf16 v[196:199], v[124:127], v[124:127], v[196:199]
    v_mfma_f32_16x16x32_bf16 v[184:187], v[240:243], v[128:131], v[184:187]
    v_mfma_f32_16x16x32_bf16 v[192:195], v[128:131], v[128:131], v[192:195]
    v_mfma_f32_16x16x32_bf16 v[188:191], v[240:243], v[132:135], v[188:191]
    v_mfma_f32_16x16x32_bf16 v[196:199], v[132:135], v[132:135], v[196:199]
    v_subrev_u32 v8, 73728, v8
    v_subrev_u32 v9, 73728, v9
    s_waitcnt vmcnt(14)
    s_barrier
    s_add_u32 s75, s72, 128
    s_and_b32 s75, s75, 1023
    s_mul_i32 s75, s75, s59
    s_add_u32 m0, s57, 131072
    s_add_u32 s75, s75, s61
    buffer_load_dwordx4 v228, s[44:47], s75 offen lds
    ds_read_b128 v[136:139], v8 offset:0
    ds_read_b128 v[140:143], v8 offset:2048
    ds_read_b128 v[144:147], v9 offset:0
    ds_read_b128 v[148:151], v9 offset:2048
    s_add_u32 m0, s57, 132096
    s_add_u32 s75, s75, s63
    buffer_load_dwordx4 v229, s[44:47], s75 offen lds
    s_add_u32 s75, s72, 256
    s_and_b32 s75, s75, 1023
    s_mul_i32 s75, s75, s59
    s_add_u32 m0, s57, 139264
    s_add_u32 s75, s75, s61
    buffer_load_dwordx4 v228, s[44:47], s75 offen lds
    s_add_u32 m0, s57, 140288
    s_add_u32 s75, s75, s63
    buffer_load_dwordx4 v229, s[44:47], s75 offen lds
    ds_read_b64_tr_b16 v[232:233], v231 offset:0
    ds_read_b64_tr_b16 v[234:235], v231 offset:1024
    ds_read_b64_tr_b16 v[236:237], v231 offset:32
    ds_read_b64_tr_b16 v[238:239], v231 offset:1056
    s_add_u32 s70, s71, 58368
    s_waitcnt lgkmcnt(0)
    s_add_u32 s75, s72, 384
    s_and_b32 s75, s75, 1023
    s_mul_i32 s75, s75, s59
    s_add_u32 m0, s57, 147456
    s_add_u32 s75, s75, s61
    buffer_load_dwordx4 v228, s[44:47], s75 offen lds
    s_add_u32 m0, s57, 148480
    s_add_u32 s75, s75, s63
    buffer_load_dwordx4 v229, s[44:47], s75 offen lds
    s_add_u32 s75, s72, 512
    s_and_b32 s75, s75, 1023
    s_mul_i32 s75, s75, s59
    s_add_u32 m0, s57, 73728
    s_add_u32 s75, s75, s61
    buffer_load_dwordx4 v228, s[44:47], s75 offen lds
    s_add_u32 m0, s57, 74752
    s_add_u32 s75, s75, s63
    buffer_load_dwordx4 v229, s[44:47], s75 offen lds
    s_waitcnt lgkmcnt(0)
    v_mfma_f32_16x16x32_bf16 v[184:187], v[240:243], v[136:139], v[184:187]
    v_mfma_f32_16x16x32_bf16 v[192:195], v[136:139], v[136:139], v[192:195]
    v_mfma_f32_16x16x32_bf16 v[188:191], v[240:243], v[140:143], v[188:191]
    v_mfma_f32_16x16x32_bf16 v[196:199], v[140:143], v[140:143], v[196:199]
    v_mfma_f32_16x16x32_bf16 v[184:187], v[240:243], v[144:147], v[184:187]
    v_mfma_f32_16x16x32_bf16 v[192:195], v[144:147], v[144:147], v[192:195]
    v_mfma_f32_16x16x32_bf16 v[188:191], v[240:243], v[148:151], v[188:191]
    v_mfma_f32_16x16x32_bf16 v[196:199], v[148:151], v[148:151], v[196:199]
    s_waitcnt vmcnt(16)
    s_barrier
    s_add_u32 s75, s72, 640
    s_and_b32 s75, s75, 1023
    s_mul_i32 s75, s75, s59
    s_add_u32 m0, s57, 81920
    s_add_u32 s75, s75, s61
    buffer_load_dwordx4 v228, s[44:47], s75 offen lds
    ds_read_b128 v[152:155], v8 offset:24576
    ds_read_b128 v[156:159], v8 offset:26624
    ds_read_b128 v[160:163], v9 offset:24576
    ds_read_b128 v[164:167], v9 offset:26624
    s_add_u32 m0, s57, 82944
    s_add_u32 s75, s75, s63
    buffer_load_dwordx4 v229, s[44:47], s75 offen lds
    s_add_u32 s75, s72, 768
    s_and_b32 s75, s75, 1023
    s_mul_i32 s75, s75, s59
    s_add_u32 m0, s57, 90112
    s_add_u32 s75, s75, s61
    buffer_load_dwordx4 v228, s[44:47], s75 offen lds
    s_add_u32 m0, s57, 91136
    s_add_u32 s75, s75, s63
    buffer_load_dwordx4 v229, s[44:47], s75 offen lds
    s_add_u32 s75, s72, 896
    s_and_b32 s75, s75, 1023
    s_mul_i32 s75, s75, s59
    s_add_u32 m0, s57, 98304
    s_add_u32 s75, s75, s61
    buffer_load_dwordx4 v228, s[44:47], s75 offen lds
    s_add_u32 m0, s57, 99328
    s_add_u32 s75, s75, s63
    buffer_load_dwordx4 v229, s[44:47], s75 offen lds
    buffer_store_dwordx4 v[232:235], v11, s[36:39], s71 offen sc1
    buffer_store_dwordx4 v[236:239], v11, s[36:39], s70 offen sc1
    s_waitcnt lgkmcnt(0)
    v_mfma_f32_16x16x32_bf16 v[184:187], v[240:243], v[152:155], v[184:187]
    v_mfma_f32_16x16x32_bf16 v[192:195], v[152:155], v[152:155], v[192:195]
    v_mfma_f32_16x16x32_bf16 v[188:191], v[240:243], v[156:159], v[188:191]
    v_mfma_f32_16x16x32_bf16 v[196:199], v[156:159], v[156:159], v[196:199]
    v_mfma_f32_16x16x32_bf16 v[184:187], v[240:243], v[160:163], v[184:187]
    v_mfma_f32_16x16x32_bf16 v[192:195], v[160:163], v[160:163], v[192:195]
    v_mfma_f32_16x16x32_bf16 v[188:191], v[240:243], v[164:167], v[188:191]
    v_mfma_f32_16x16x32_bf16 v[196:199], v[164:167], v[164:167], v[196:199]
    s_waitcnt vmcnt(18)
    s_barrier
    ds_read_b128 v[168:171], v8 offset:49152
    ds_read_b128 v[172:175], v8 offset:51200
    ds_read_b128 v[176:179], v9 offset:49152
    ds_read_b128 v[180:183], v9 offset:51200
    s_waitcnt lgkmcnt(0)
    v_mfma_f32_16x16x32_bf16 v[184:187], v[240:243], v[168:171], v[184:187]
    v_mfma_f32_16x16x32_bf16 v[192:195], v[168:171], v[168:171], v[192:195]
    v_mfma_f32_16x16x32_bf16 v[188:191], v[240:243], v[172:175], v[188:191]
    v_mfma_f32_16x16x32_bf16 v[196:199], v[172:175], v[172:175], v[196:199]
    v_mfma_f32_16x16x32_bf16 v[184:187], v[240:243], v[176:179], v[184:187]
    v_mfma_f32_16x16x32_bf16 v[192:195], v[176:179], v[176:179], v[192:195]
    v_mfma_f32_16x16x32_bf16 v[188:191], v[240:243], v[180:183], v[188:191]
    v_mfma_f32_16x16x32_bf16 v[196:199], v[180:183], v[180:183], v[196:199]
    s_lshl_b32 s60, s52, 4
    s_lshr_b32 s61, s55, 1
    s_lshl_b32 s61, s61, 3
    s_add_u32 s60, s60, s61
    s_lshl_b32 s61, s78, 2
    s_add_u32 s60, s60, s61
    s_and_b32 s61, s55, 1
    s_lshl_b32 s61, s61, 1
    s_add_u32 s60, s60, s61
    s_mul_i32 s60, s60, 58368
    s_lshl_b32 s61, s53, 12
    s_add_u32 s60, s60, s61
    s_add_u32 s60, s60, 2048
    s_lshl_b32 s61, s79, 3
    s_add_u32 s60, s60, s61
    s_add_u32 s61, s60, 58368
    s_or_b32 s63, s52, s55
    s_or_b32 s63, s63, s78
    s_cmp_eq_u32 s63, 0
    s_cselect_b32 s76, 0xffff, 0
    s_mov_b32 s77, 0
    s_lshl_b32 s64, s78, 3
    s_add_u32 s64, s64, s52
    s_lshl_b32 s64, s64, 10
    s_lshl_b32 s65, s55, 8
    s_add_u32 s64, s64, s65
    s_add_u32 s64, s64, 0xa00000
    s_lshl_b32 s63, s55, 7
    s_and_b32 s66, s53, 1
    s_lshl_b32 s66, s66, 3
    s_add_u32 s66, s66, 4
    s_lshl_b32 s67, s66, 14
    s_add_u32 s67, s67, s64
    s_lshl_b32 s65, s79, 8
    s_add_u32 s67, s67, s65
    s_lshl_b32 s65, s79, 4
    s_sub_u32 s65, 0x400, s65
    s_lshl_b32 s66, s66, 6
    s_add_u32 s66, s66, 0xb10000
    v_lshl_add_u32 v14, v2, 2, s66
    v_and_b32 v21, 1, v3
    v_mul_u32_u24 v21, 0x44000, v21
    v_lshrrev_b32 v22, 1, v3
    v_lshl_add_u32 v21, v22, 14, v21
    v_lshl_add_u32 v13, v2, 4, v21
    v_lshlrev_b32 v15, 2, v2
    v_add_u32 v15, 155648, v15
    v_xor_b32 v10, s79, v15
    v_add_u32 v17, s63, v15
    s_mov_b32 s68, 0x22222222
    s_mov_b32 s69, 0x22222222
    v_cndmask_b32 v192, v192, v193, s[68:69]
    v_cndmask_b32 v196, v196, v197, s[68:69]
    s_mov_b32 s68, 0x44444444
    s_mov_b32 s69, 0x44444444
    v_cndmask_b32 v192, v192, v194, s[68:69]
    v_cndmask_b32 v196, v196, v198, s[68:69]
    s_mov_b32 s68, 0x88888888
    s_mov_b32 s69, 0x88888888
    v_cndmask_b32 v192, v192, v195, s[68:69]
    v_cndmask_b32 v196, v196, v199, s[68:69]
    v_mul_f32 v184, 0x3b000000, v184
    v_mul_f32 v188, 0x3b000000, v188
    v_mul_f32 v192, 0x3b000000, v192
    v_mul_f32 v196, 0x3b000000, v196
    v_fma_f32 v192, -v184, v184, v192
    v_fma_f32 v196, -v188, v188, v196
    v_max_f32 v192, 0, v192
    v_max_f32 v196, 0, v196
    v_cvt_pk_bf16_f32 v185, v184, v192
    v_cvt_pk_bf16_f32 v189, v188, v196
    v_lshlrev_b32 v184, 16, v185
    v_lshlrev_b32 v188, 16, v189
    v_and_b32 v192, 0xffff0000, v185
    v_and_b32 v196, 0xffff0000, v189
    v_add_f32 v192, 0x3727c5ac, v192
    v_add_f32 v196, 0x3727c5ac, v196
    v_cvt_pk_bf16_f32 v185, v192, v192
    v_cvt_pk_bf16_f32 v189, v196, v196
    v_lshlrev_b32 v192, 16, v185
    v_lshlrev_b32 v196, 16, v189
    v_sqrt_f32 v192, v192
    v_sqrt_f32 v196, v196
    s_nop 0
    v_cvt_pk_bf16_f32 v185, v192, v192
    v_cvt_pk_bf16_f32 v189, v196, v196
    v_lshlrev_b32 v192, 16, v185
    v_lshlrev_b32 v196, 16, v189
    v_rcp_f32 v192, v192
    v_rcp_f32 v196, v196
    s_nop 0
    s_mov_b32 exec_lo, 0x00f0000f
    s_mov_b32 exec_hi, 0xf0000f00
    ds_write_b32 v17, v184 offset:512
    ds_write_b32 v17, v192 offset:1024
    ds_write_b32 v17, v188 offset:576
    ds_write_b32 v17, v196 offset:1088
    s_mov_b64 exec, -1
    v_xor_b32 v224, 0x1000, v4
    v_xor_b32 v225, 0x1000, v5
    v_xor_b32 v226, 0x1000, v6
    v_xor_b32 v227, 0x1000, v7
    s_waitcnt vmcnt(10)
    s_waitcnt lgkmcnt(0)
    s_barrier
    s_setprio 0
    s_cmp_lt_u32 s53, 14
    s_cbranch_scc1 K1_PB_F
    s_branch K1_PB_D
K1_CONS:
    v_lshl_add_u32 v16, s53, 4, v2
    v_cmp_eq_u32 vcc, 0, v16
    v_mov_b32 v17, 0x100
    v_mov_b32 v19, 0xbe800000
    v_cndmask_b32 v16, v16, v17, vcc
    v_cndmask_b32 v19, 0, v19, vcc
    v_cvt_f32_u32 v16, v16
    v_mul_f32 v16, 0x3b000000, v16
    s_and_b32 s65, s55, 1
    s_lshl_b32 s64, s73, 1
    s_add_u32 s64, s64, s65
    s_lshl_b32 s64, s64, 5
    s_cmp_eq_u32 s65, 0
    s_cselect_b32 s65, 1.0, -1.0
    s_cselect_b32 s66, 1.0, 0x40400000
    v_lshl_add_u32 v17, v3, 3, s64
    v_cvt_f32_u32 v17, v17
    v_fma_f32 v164, v17, v16, v19
    v_fract_f32 v164, v164
    v_add_f32 v165, v164, v16
    v_add_f32 v166, v165, v16
    v_add_f32 v167, v166, v16
    v_add_f32 v168, v167, v16
    v_add_f32 v169, v168, v16
    v_add_f32 v170, v169, v16
    v_add_f32 v171, v170, v16
    v_mul_f32 v16, 0x42000000, v16
    v_fract_f32 v16, v16
    v_mul_f32 v17, s66, v16
    v_mul_f32 v16, s65, v16
    v_sin_f32 v172, -v164
    v_add_f32 v164, v164, v16
    v_sin_f32 v173, -v165
    v_add_f32 v165, v165, v16
    v_sin_f32 v174, -v166
    v_add_f32 v166, v166, v16
    v_sin_f32 v175, -v167
    v_add_f32 v167, v167, v16
    v_sin_f32 v176, -v168
    v_add_f32 v168, v168, v16
    v_sin_f32 v177, -v169
    v_add_f32 v169, v169, v16
    v_sin_f32 v178, -v170
    v_add_f32 v170, v170, v16
    v_sin_f32 v179, -v171
    v_add_f32 v171, v171, v16
    v_cvt_pk_bf16_f32 v88, v172, v173
    v_cvt_pk_bf16_f32 v89, v174, v175
    v_cvt_pk_bf16_f32 v90, v176, v177
    v_cvt_pk_bf16_f32 v91, v178, v179
    v_sin_f32 v172, -v164
    v_add_f32 v164, v164, v17
    v_sin_f32 v173, -v165
    v_add_f32 v165, v165, v17
    v_sin_f32 v174, -v166
    v_add_f32 v166, v166, v17
    v_sin_f32 v175, -v167
    v_add_f32 v167, v167, v17
    v_sin_f32 v176, -v168
    v_add_f32 v168, v168, v17
    v_sin_f32 v177, -v169
    v_add_f32 v169, v169, v17
    v_sin_f32 v178, -v170
    v_add_f32 v170, v170, v17
    v_sin_f32 v179, -v171
    v_add_f32 v171, v171, v17
    v_cvt_pk_bf16_f32 v92, v172, v173
    v_cvt_pk_bf16_f32 v93, v174, v175
    v_cvt_pk_bf16_f32 v94, v176, v177
    v_cvt_pk_bf16_f32 v95, v178, v179
    v_sin_f32 v172, -v164
    v_add_f32 v164, v164, v16
    v_sin_f32 v173, -v165
    v_add_f32 v165, v165, v16
    v_sin_f32 v174, -v166
    v_add_f32 v166, v166, v16
    v_sin_f32 v175, -v167
    v_add_f32 v167, v167, v16
    v_sin_f32 v176, -v168
    v_add_f32 v168, v168, v16
    v_sin_f32 v177, -v169
    v_add_f32 v169, v169, v16
    v_sin_f32 v178, -v170
    v_add_f32 v170, v170, v16
    v_sin_f32 v179, -v171
    v_add_f32 v171, v171, v16
    v_cvt_pk_bf16_f32 v96, v172, v173
    v_cvt_pk_bf16_f32 v97, v174, v175
    v_cvt_pk_bf16_f32 v98, v176, v177
    v_cvt_pk_bf16_f32 v99, v178, v179
    v_sin_f32 v172, -v164
    v_add_f32 v164, v164, v17
    v_sin_f32 v173, -v165
    v_add_f32 v165, v165, v17
    v_sin_f32 v174, -v166
    v_add_f32 v166, v166, v17
    v_sin_f32 v175, -v167
    v_add_f32 v167, v167, v17
    v_sin_f32 v176, -v168
    v_add_f32 v168, v168, v17
    v_sin_f32 v177, -v169
    v_add_f32 v169, v169, v17
    v_sin_f32 v178, -v170
    v_add_f32 v170, v170, v17
    v_sin_f32 v179, -v171
    v_add_f32 v171, v171, v17
    v_cvt_pk_bf16_f32 v100, v172, v173
    v_cvt_pk_bf16_f32 v101, v174, v175
    v_cvt_pk_bf16_f32 v102, v176, v177
    v_cvt_pk_bf16_f32 v103, v178, v179
    v_sin_f32 v172, -v164
    v_add_f32 v164, v164, v16
    v_sin_f32 v173, -v165
    v_add_f32 v165, v165, v16
    v_sin_f32 v174, -v166
    v_add_f32 v166, v166, v16
    v_sin_f32 v175, -v167
    v_add_f32 v167, v167, v16
    v_sin_f32 v176, -v168
    v_add_f32 v168, v168, v16
    v_sin_f32 v177, -v169
    v_add_f32 v169, v169, v16
    v_sin_f32 v178, -v170
    v_add_f32 v170, v170, v16
    v_sin_f32 v179, -v171
    v_add_f32 v171, v171, v16
    v_cvt_pk_bf16_f32 v104, v172, v173
    v_cvt_pk_bf16_f32 v105, v174, v175
    v_cvt_pk_bf16_f32 v106, v176, v177
    v_cvt_pk_bf16_f32 v107, v178, v179
    v_sin_f32 v172, -v164
    v_add_f32 v164, v164, v17
    v_sin_f32 v173, -v165
    v_add_f32 v165, v165, v17
    v_sin_f32 v174, -v166
    v_add_f32 v166, v166, v17
    v_sin_f32 v175, -v167
    v_add_f32 v167, v167, v17
    v_sin_f32 v176, -v168
    v_add_f32 v168, v168, v17
    v_sin_f32 v177, -v169
    v_add_f32 v169, v169, v17
    v_sin_f32 v178, -v170
    v_add_f32 v170, v170, v17
    v_sin_f32 v179, -v171
    v_add_f32 v171, v171, v17
    v_cvt_pk_bf16_f32 v108, v172, v173
    v_cvt_pk_bf16_f32 v109, v174, v175
    v_cvt_pk_bf16_f32 v110, v176, v177
    v_cvt_pk_bf16_f32 v111, v178, v179
    v_sin_f32 v172, -v164
    v_add_f32 v164, v164, v16
    v_sin_f32 v173, -v165
    v_add_f32 v165, v165, v16
    v_sin_f32 v174, -v166
    v_add_f32 v166, v166, v16
    v_sin_f32 v175, -v167
    v_add_f32 v167, v167, v16
    v_sin_f32 v176, -v168
    v_add_f32 v168, v168, v16
    v_sin_f32 v177, -v169
    v_add_f32 v169, v169, v16
    v_sin_f32 v178, -v170
    v_add_f32 v170, v170, v16
    v_sin_f32 v179, -v171
    v_add_f32 v171, v171, v16
    v_cvt_pk_bf16_f32 v112, v172, v173
    v_cvt_pk_bf16_f32 v113, v174, v175
    v_cvt_pk_bf16_f32 v114, v176, v177
    v_cvt_pk_bf16_f32 v115, v178, v179
    v_sin_f32 v172, -v164
    v_add_f32 v164, v164, v17
    v_sin_f32 v173, -v165
    v_add_f32 v165, v165, v17
    v_sin_f32 v174, -v166
    v_add_f32 v166, v166, v17
    v_sin_f32 v175, -v167
    v_add_f32 v167, v167, v17
    v_sin_f32 v176, -v168
    v_add_f32 v168, v168, v17
    v_sin_f32 v177, -v169
    v_add_f32 v169, v169, v17
    v_sin_f32 v178, -v170
    v_add_f32 v170, v170, v17
    v_sin_f32 v179, -v171
    v_add_f32 v171, v171, v17
    v_cvt_pk_bf16_f32 v116, v172, v173
    v_cvt_pk_bf16_f32 v117, v174, v175
    v_cvt_pk_bf16_f32 v118, v176, v177
    v_cvt_pk_bf16_f32 v119, v178, v179
    v_sin_f32 v172, -v164
    v_add_f32 v164, v164, v16
    v_sin_f32 v173, -v165
    v_add_f32 v165, v165, v16
    v_sin_f32 v174, -v166
    v_add_f32 v166, v166, v16
    v_sin_f32 v175, -v167
    v_add_f32 v167, v167, v16
    v_sin_f32 v176, -v168
    v_add_f32 v168, v168, v16
    v_sin_f32 v177, -v169
    v_add_f32 v169, v169, v16
    v_sin_f32 v178, -v170
    v_add_f32 v170, v170, v16
    v_sin_f32 v179, -v171
    v_add_f32 v171, v171, v16
    v_cvt_pk_bf16_f32 v120, v172, v173
    v_cvt_pk_bf16_f32 v121, v174, v175
    v_cvt_pk_bf16_f32 v122, v176, v177
    v_cvt_pk_bf16_f32 v123, v178, v179
    v_sin_f32 v172, -v164
    v_add_f32 v164, v164, v17
    v_sin_f32 v173, -v165
    v_add_f32 v165, v165, v17
    v_sin_f32 v174, -v166
    v_add_f32 v166, v166, v17
    v_sin_f32 v175, -v167
    v_add_f32 v167, v167, v17
    v_sin_f32 v176, -v168
    v_add_f32 v168, v168, v17
    v_sin_f32 v177, -v169
    v_add_f32 v169, v169, v17
    v_sin_f32 v178, -v170
    v_add_f32 v170, v170, v17
    v_sin_f32 v179, -v171
    v_add_f32 v171, v171, v17
    v_cvt_pk_bf16_f32 v124, v172, v173
    v_cvt_pk_bf16_f32 v125, v174, v175
    v_cvt_pk_bf16_f32 v126, v176, v177
    v_cvt_pk_bf16_f32 v127, v178, v179
    v_sin_f32 v172, -v164
    v_add_f32 v164, v164, v16
    v_sin_f32 v173, -v165
    v_add_f32 v165, v165, v16
    v_sin_f32 v174, -v166
    v_add_f32 v166, v166, v16
    v_sin_f32 v175, -v167
    v_add_f32 v167, v167, v16
    v_sin_f32 v176, -v168
    v_add_f32 v168, v168, v16
    v_sin_f32 v177, -v169
    v_add_f32 v169, v169, v16
    v_sin_f32 v178, -v170
    v_add_f32 v170, v170, v16
    v_sin_f32 v179, -v171
    v_add_f32 v171, v171, v16
    v_cvt_pk_bf16_f32 v128, v172, v173
    v_cvt_pk_bf16_f32 v129, v174, v175
    v_cvt_pk_bf16_f32 v130, v176, v177
    v_cvt_pk_bf16_f32 v131, v178, v179
    v_sin_f32 v172, -v164
    v_add_f32 v164, v164, v17
    v_sin_f32 v173, -v165
    v_add_f32 v165, v165, v17
    v_sin_f32 v174, -v166
    v_add_f32 v166, v166, v17
    v_sin_f32 v175, -v167
    v_add_f32 v167, v167, v17
    v_sin_f32 v176, -v168
    v_add_f32 v168, v168, v17
    v_sin_f32 v177, -v169
    v_add_f32 v169, v169, v17
    v_sin_f32 v178, -v170
    v_add_f32 v170, v170, v17
    v_sin_f32 v179, -v171
    v_add_f32 v171, v171, v17
    v_cvt_pk_bf16_f32 v132, v172, v173
    v_cvt_pk_bf16_f32 v133, v174, v175
    v_cvt_pk_bf16_f32 v134, v176, v177
    v_cvt_pk_bf16_f32 v135, v178, v179
    v_sin_f32 v172, -v164
    v_add_f32 v164, v164, v16
    v_sin_f32 v173, -v165
    v_add_f32 v165, v165, v16
    v_sin_f32 v174, -v166
    v_add_f32 v166, v166, v16
    v_sin_f32 v175, -v167
    v_add_f32 v167, v167, v16
    v_sin_f32 v176, -v168
    v_add_f32 v168, v168, v16
    v_sin_f32 v177, -v169
    v_add_f32 v169, v169, v16
    v_sin_f32 v178, -v170
    v_add_f32 v170, v170, v16
    v_sin_f32 v179, -v171
    v_add_f32 v171, v171, v16
    v_cvt_pk_bf16_f32 v136, v172, v173
    v_cvt_pk_bf16_f32 v137, v174, v175
    v_cvt_pk_bf16_f32 v138, v176, v177
    v_cvt_pk_bf16_f32 v139, v178, v179
    v_sin_f32 v172, -v164
    v_add_f32 v164, v164, v17
    v_sin_f32 v173, -v165
    v_add_f32 v165, v165, v17
    v_sin_f32 v174, -v166
    v_add_f32 v166, v166, v17
    v_sin_f32 v175, -v167
    v_add_f32 v167, v167, v17
    v_sin_f32 v176, -v168
    v_add_f32 v168, v168, v17
    v_sin_f32 v177, -v169
    v_add_f32 v169, v169, v17
    v_sin_f32 v178, -v170
    v_add_f32 v170, v170, v17
    v_sin_f32 v179, -v171
    v_add_f32 v171, v171, v17
    v_cvt_pk_bf16_f32 v140, v172, v173
    v_cvt_pk_bf16_f32 v141, v174, v175
    v_cvt_pk_bf16_f32 v142, v176, v177
    v_cvt_pk_bf16_f32 v143, v178, v179
    v_sin_f32 v172, -v164
    v_add_f32 v164, v164, v16
    v_sin_f32 v173, -v165
    v_add_f32 v165, v165, v16
    v_sin_f32 v174, -v166
    v_add_f32 v166, v166, v16
    v_sin_f32 v175, -v167
    v_add_f32 v167, v167, v16
    v_sin_f32 v176, -v168
    v_add_f32 v168, v168, v16
    v_sin_f32 v177, -v169
    v_add_f32 v169, v169, v16
    v_sin_f32 v178, -v170
    v_add_f32 v170, v170, v16
    v_sin_f32 v179, -v171
    v_add_f32 v171, v171, v16
    v_cvt_pk_bf16_f32 v144, v172, v173
    v_cvt_pk_bf16_f32 v145, v174, v175
    v_cvt_pk_bf16_f32 v146, v176, v177
    v_cvt_pk_bf16_f32 v147, v178, v179
    v_sin_f32 v172, -v164
    v_sin_f32 v173, -v165
    v_sin_f32 v174, -v166
    v_sin_f32 v175, -v167
    v_sin_f32 v176, -v168
    v_sin_f32 v177, -v169
    v_sin_f32 v178, -v170
    v_sin_f32 v179, -v171
    s_nop 0
    v_cvt_pk_bf16_f32 v148, v172, v173
    v_cvt_pk_bf16_f32 v149, v174, v175
    v_cvt_pk_bf16_f32 v150, v176, v177
    v_cvt_pk_bf16_f32 v151, v178, v179
    v_lshrrev_b32 v16, 2, v2
    v_and_b32 v17, 1, v3
    v_lshrrev_b32 v18, 1, v16
    v_lshl_add_u32 v18, v17, 1, v18
    v_lshl_add_u32 v16, v3, 3, v16
    v_lshlrev_b32 v16, 7, v16
    v_lshl_add_u32 v16, v18, 5, v16
    v_and_b32 v17, 3, v2
    v_lshl_add_u32 v16, v17, 3, v16
    s_and_b32 s64, s55, 1
    s_lshl_b32 s64, s64, 12
    s_and_b32 s79, s55, 2
    s_lshl_b32 s79, s79, 5
    s_or_b32 s64, s64, s79
    s_lshl_b32 s79, s79, 1
    v_xor_b32 v16, s64, v16
    v_xor_b32 v4, 0, v16
    v_xor_b32 v5, 32, v16
    v_xor_b32 v6, 64, v16
    v_xor_b32 v7, 96, v16
    v_lshlrev_b32 v11, 4, v1
    v_lshlrev_b32 v12, 4, v3
    v_add_u32 v12, 155648, v12
    v_xor_b32 v160, 0x1000, v4
    v_xor_b32 v161, 0x1000, v5
    v_xor_b32 v162, 0x1000, v6
    v_xor_b32 v163, 0x1000, v7
    v_lshrrev_b32 v16, 1, v2
    v_xor_b32 v16, v16, v3
    v_lshlrev_b32 v16, 4, v16
    v_lshl_add_u32 v16, v2, 7, v16
    v_add_u32 v8, s62, v16
    v_add_u32 v8, 0x2000, v8
    s_and_b32 s64, s55, 1
    s_lshl_b32 s64, s64, 6
    v_xor_b32 v8, s64, v8
    v_xor_b32 v9, 64, v8
    v_mov_b32 v240, 0x3f803f80
    v_mov_b32 v241, 0x3f803f80
    v_mov_b32 v242, 0x3f803f80
    v_mov_b32 v243, 0x3f803f80
    s_lshl_b32 s60, s52, 4
    s_lshr_b32 s61, s55, 1
    s_lshl_b32 s61, s61, 3
    s_add_u32 s60, s60, s61
    s_lshl_b32 s61, s78, 2
    s_add_u32 s60, s60, s61
    s_and_b32 s61, s55, 1
    s_lshl_b32 s61, s61, 1
    s_add_u32 s60, s60, s61
    s_mul_i32 s60, s60, 58368
    s_lshl_b32 s61, s53, 12
    s_add_u32 s60, s60, s61
    s_lshl_b32 s61, s79, 3
    s_add_u32 s60, s60, s61
    s_add_u32 s61, s60, 58368
    s_or_b32 s63, s52, s55
    s_or_b32 s63, s63, s78
    s_cmp_eq_u32 s63, 0
    s_cselect_b32 s76, 0xffff, 0
    s_mov_b32 s77, 0
    s_lshl_b32 s64, s78, 3
    s_add_u32 s64, s64, s52
    s_lshl_b32 s64, s64, 10
    s_lshl_b32 s65, s55, 8
    s_add_u32 s64, s64, s65
    s_add_u32 s64, s64, 0xa00000
    s_lshl_b32 s63, s55, 7
    s_and_b32 s66, s53, 1
    s_lshl_b32 s66, s66, 3
    s_lshl_b32 s67, s66, 14
    s_add_u32 s67, s67, s64
    s_lshl_b32 s65, s79, 8
    s_add_u32 s67, s67, s65
    s_lshl_b32 s65, s79, 4
    s_sub_u32 s65, 0x400, s65
    s_lshl_b32 s66, s66, 6
    s_add_u32 s66, s66, 0xb10000
    v_lshl_add_u32 v14, v2, 2, s66
    v_and_b32 v21, 1, v3
    v_mul_u32_u24 v21, 0x44000, v21
    v_lshrrev_b32 v22, 1, v3
    v_lshl_add_u32 v21, v22, 14, v21
    v_lshl_add_u32 v13, v2, 4, v21
    v_lshlrev_b32 v15, 2, v2
    v_add_u32 v15, 155648, v15
    v_xor_b32 v10, s79, v15
    s_waitcnt lgkmcnt(0)
    s_mov_b32 s36, s28
    s_and_b32 s37, s29, 0xffff
    s_mov_b32 s38, 0xb12000
    s_mov_b32 s39, 0x00020000
    s_cmp_lt_u32 s53, 14
    s_cbranch_scc0 K1_VAR_D
K1_VAR_F:
    s_barrier
    ds_read_b128 v[64:67], v8 offset:0
    ds_read_b128 v[68:71], v8 offset:2048
    ds_read_b64_tr_b16 v[32:33], v4 offset:0
    ds_read_b64_tr_b16 v[34:35], v4 offset:512
    ds_read_b64_tr_b16 v[36:37], v5 offset:0
    ds_read_b64_tr_b16 v[38:39], v5 offset:512
    ds_read_b64_tr_b16 v[40:41], v6 offset:0
    ds_read_b64_tr_b16 v[42:43], v6 offset:512
    ds_read_b64_tr_b16 v[44:45], v7 offset:0
    ds_read_b64_tr_b16 v[46:47], v7 offset:512
    ds_read_b128 v[72:75], v9 offset:0
    ds_read_b128 v[76:79], v9 offset:2048
    ds_read_b64_tr_b16 v[48:49], v160 offset:0
    ds_read_b64_tr_b16 v[50:51], v160 offset:512
    s_waitcnt lgkmcnt(10)
    v_mfma_f32_16x16x32_bf16 v[184:187], v[32:35], v[64:67], 0
    ds_read_b64_tr_b16 v[52:53], v161 offset:0
    v_mfma_f32_16x16x32_bf16 v[188:191], v[32:35], v[68:71], 0
    ds_read_b64_tr_b16 v[54:55], v161 offset:512
    v_mfma_f32_16x16x32_bf16 v[152:155], v[240:243], v[32:35], 0
    s_waitcnt lgkmcnt(10)
    v_mfma_f32_16x16x32_bf16 v[192:195], v[36:39], v[64:67], 0
    ds_read_b64_tr_b16 v[56:57], v162 offset:0
    v_mfma_f32_16x16x32_bf16 v[196:199], v[36:39], v[68:71], 0
    ds_read_b64_tr_b16 v[58:59], v162 offset:512
    v_mfma_f32_16x16x32_bf16 v[156:159], v[240:243], v[36:39], 0
    s_waitcnt lgkmcnt(10)
    v_mfma_f32_16x16x32_bf16 v[200:203], v[40:43], v[64:67], 0
    ds_read_b64_tr_b16 v[60:61], v163 offset:0
    v_mfma_f32_16x16x32_bf16 v[204:207], v[40:43], v[68:71], 0
    ds_read_b64_tr_b16 v[62:63], v163 offset:512
    s_barrier
    s_waitcnt lgkmcnt(10)
    v_mfma_f32_16x16x32_bf16 v[208:211], v[44:47], v[64:67], 0
    ds_read_b128 v[80:83], v8 offset:24576
    ds_read_b128 v[84:87], v8 offset:26624
    v_mfma_f32_16x16x32_bf16 v[212:215], v[44:47], v[68:71], 0
    ds_read_b64_tr_b16 v[32:33], v4 offset:24576
    v_mfma_f32_16x16x32_bf16 v[216:219], v[64:67], v[88:91], 0
    ds_read_b64_tr_b16 v[34:35], v4 offset:25088
    v_mfma_f32_16x16x32_bf16 v[220:223], v[68:71], v[88:91], 0
    s_waitcnt lgkmcnt(10)
    v_mfma_f32_16x16x32_bf16 v[184:187], v[48:51], v[72:75], v[184:187]
    ds_read_b64_tr_b16 v[36:37], v5 offset:24576
    v_mfma_f32_16x16x32_bf16 v[188:191], v[48:51], v[76:79], v[188:191]
    ds_read_b64_tr_b16 v[38:39], v5 offset:25088
    s_waitcnt lgkmcnt(10)
    v_mfma_f32_16x16x32_bf16 v[192:195], v[52:55], v[72:75], v[192:195]
    ds_read_b64_tr_b16 v[40:41], v6 offset:24576
    v_mfma_f32_16x16x32_bf16 v[196:199], v[52:55], v[76:79], v[196:199]
    ds_read_b64_tr_b16 v[42:43], v6 offset:25088
    s_waitcnt lgkmcnt(10)
    v_mfma_f32_16x16x32_bf16 v[200:203], v[56:59], v[72:75], v[200:203]
    ds_read_b64_tr_b16 v[44:45], v7 offset:24576
    v_mfma_f32_16x16x32_bf16 v[204:207], v[56:59], v[76:79], v[204:207]
    ds_read_b64_tr_b16 v[46:47], v7 offset:25088
    s_waitcnt lgkmcnt(10)
    v_mfma_f32_16x16x32_bf16 v[208:211], v[60:63], v[72:75], v[208:211]
    ds_read_b128 v[64:67], v9 offset:24576
    ds_read_b128 v[68:71], v9 offset:26624
    v_mfma_f32_16x16x32_bf16 v[212:215], v[60:63], v[76:79], v[212:215]
    ds_read_b64_tr_b16 v[48:49], v160 offset:24576
    v_mfma_f32_16x16x32_bf16 v[216:219], v[72:75], v[92:95], v[216:219]
    ds_read_b64_tr_b16 v[50:51], v160 offset:25088
    v_mfma_f32_16x16x32_bf16 v[220:223], v[76:79], v[92:95], v[220:223]
    s_waitcnt lgkmcnt(10)
    v_mfma_f32_16x16x32_bf16 v[184:187], v[32:35], v[80:83], v[184:187]
    ds_read_b64_tr_b16 v[52:53], v161 offset:24576
    v_mfma_f32_16x16x32_bf16 v[188:191], v[32:35], v[84:87], v[188:191]
    ds_read_b64_tr_b16 v[54:55], v161 offset:25088
    v_mfma_f32_16x16x32_bf16 v[152:155], v[240:243], v[32:35], v[152:155]
    s_waitcnt lgkmcnt(10)
    v_mfma_f32_16x16x32_bf16 v[192:195], v[36:39], v[80:83], v[192:195]
    ds_read_b64_tr_b16 v[56:57], v162 offset:24576
    v_mfma_f32_16x16x32_bf16 v[196:199], v[36:39], v[84:87], v[196:199]
    ds_read_b64_tr_b16 v[58:59], v162 offset:25088
    v_mfma_f32_16x16x32_bf16 v[156:159], v[240:243], v[36:39], v[156:159]
    s_waitcnt lgkmcnt(10)
    v_mfma_f32_16x16x32_bf16 v[200:203], v[40:43], v[80:83], v[200:203]
    ds_read_b64_tr_b16 v[60:61], v163 offset:24576
    v_mfma_f32_16x16x32_bf16 v[204:207], v[40:43], v[84:87], v[204:207]
    ds_read_b64_tr_b16 v[62:63], v163 offset:25088
    s_barrier
    s_waitcnt lgkmcnt(10)
    v_mfma_f32_16x16x32_bf16 v[208:211], v[44:47], v[80:83], v[208:211]
    ds_read_b128 v[72:75], v8 offset:49152
    ds_read_b128 v[76:79], v8 offset:51200
    v_mfma_f32_16x16x32_bf16 v[212:215], v[44:47], v[84:87], v[212:215]
    ds_read_b64_tr_b16 v[32:33], v4 offset:49152
    v_mfma_f32_16x16x32_bf16 v[216:219], v[80:83], v[96:99], v[216:219]
    ds_read_b64_tr_b16 v[34:35], v4 offset:49664
    v_mfma_f32_16x16x32_bf16 v[220:223], v[84:87], v[96:99], v[220:223]
    s_waitcnt lgkmcnt(10)
    v_mfma_f32_16x16x32_bf16 v[184:187], v[48:51], v[64:67], v[184:187]
    ds_read_b64_tr_b16 v[36:37], v5 offset:49152
    v_mfma_f32_16x16x32_bf16 v[188:191], v[48:51], v[68:71], v[188:191]
    ds_read_b64_tr_b16 v[38:39], v5 offset:49664
    s_waitcnt lgkmcnt(10)
    v_mfma_f32_16x16x32_bf16 v[192:195], v[52:55], v[64:67], v[192:195]
    ds_read_b64_tr_b16 v[40:41], v6 offset:49152
    v_mfma_f32_16x16x32_bf16 v[196:199], v[52:55], v[68:71], v[196:199]
    ds_read_b64_tr_b16 v[42:43], v6 offset:49664
    s_waitcnt lgkmcnt(10)
    v_mfma_f32_16x16x32_bf16 v[200:203], v[56:59], v[64:67], v[200:203]
    ds_read_b64_tr_b16 v[44:45], v7 offset:49152
    v_mfma_f32_16x16x32_bf16 v[204:207], v[56:59], v[68:71], v[204:207]
    ds_read_b64_tr_b16 v[46:47], v7 offset:49664
    s_waitcnt lgkmcnt(10)
    v_mfma_f32_16x16x32_bf16 v[208:211], v[60:63], v[64:67], v[208:211]
    ds_read_b128 v[80:83], v9 offset:49152
    ds_read_b128 v[84:87], v9 offset:51200
    v_mfma_f32_16x16x32_bf16 v[212:215], v[60:63], v[68:71], v[212:215]
    ds_read_b64_tr_b16 v[48:49], v160 offset:49152
    v_mfma_f32_16x16x32_bf16 v[216:219], v[64:67], v[100:103], v[216:219]
    ds_read_b64_tr_b16 v[50:51], v160 offset:49664
    v_mfma_f32_16x16x32_bf16 v[220:223], v[68:71], v[100:103], v[220:223]
    s_waitcnt lgkmcnt(10)
    v_mfma_f32_16x16x32_bf16 v[184:187], v[32:35], v[72:75], v[184:187]
    ds_read_b64_tr_b16 v[52:53], v161 offset:49152
    v_mfma_f32_16x16x32_bf16 v[188:191], v[32:35], v[76:79], v[188:191]
    ds_read_b64_tr_b16 v[54:55], v161 offset:49664
    v_mfma_f32_16x16x32_bf16 v[152:155], v[240:243], v[32:35], v[152:155]
    s_waitcnt lgkmcnt(10)
    v_mfma_f32_16x16x32_bf16 v[192:195], v[36:39], v[72:75], v[192:195]
    ds_read_b64_tr_b16 v[56:57], v162 offset:49152
    v_mfma_f32_16x16x32_bf16 v[196:199], v[36:39], v[76:79], v[196:199]
    ds_read_b64_tr_b16 v[58:59], v162 offset:49664
    v_mfma_f32_16x16x32_bf16 v[156:159], v[240:243], v[36:39], v[156:159]
    s_waitcnt lgkmcnt(10)
    v_mfma_f32_16x16x32_bf16 v[200:203], v[40:43], v[72:75], v[200:203]
    ds_read_b64_tr_b16 v[60:61], v163 offset:49152
    v_mfma_f32_16x16x32_bf16 v[204:207], v[40:43], v[76:79], v[204:207]
    ds_read_b64_tr_b16 v[62:63], v163 offset:49664
    v_add_u32 v4, 73728, v4
    v_add_u32 v5, 73728, v5
    v_add_u32 v6, 73728, v6
    v_add_u32 v7, 73728, v7
    v_add_u32 v8, 73728, v8
    v_add_u32 v9, 73728, v9
    v_add_u32 v160, 73728, v160
    v_add_u32 v161, 73728, v161
    v_add_u32 v162, 73728, v162
    v_add_u32 v163, 73728, v163
    s_barrier
    s_waitcnt lgkmcnt(10)
    v_mfma_f32_16x16x32_bf16 v[208:211], v[44:47], v[72:75], v[208:211]
    ds_read_b128 v[64:67], v8 offset:0
    ds_read_b128 v[68:71], v8 offset:2048
    v_mfma_f32_16x16x32_bf16 v[212:215], v[44:47], v[76:79], v[212:215]
    ds_read_b64_tr_b16 v[32:33], v4 offset:0
    v_mfma_f32_16x16x32_bf16 v[216:219], v[72:75], v[104:107], v[216:219]
    ds_read_b64_tr_b16 v[34:35], v4 offset:512
    v_mfma_f32_16x16x32_bf16 v[220:223], v[76:79], v[104:107], v[220:223]
    s_waitcnt lgkmcnt(10)
    v_mfma_f32_16x16x32_bf16 v[184:187], v[48:51], v[80:83], v[184:187]
    ds_read_b64_tr_b16 v[36:37], v5 offset:0
    v_mfma_f32_16x16x32_bf16 v[188:191], v[48:51], v[84:87], v[188:191]
    ds_read_b64_tr_b16 v[38:39], v5 offset:512
    s_waitcnt lgkmcnt(10)
    v_mfma_f32_16x16x32_bf16 v[192:195], v[52:55], v[80:83], v[192:195]
    ds_read_b64_tr_b16 v[40:41], v6 offset:0
    v_mfma_f32_16x16x32_bf16 v[196:199], v[52:55], v[84:87], v[196:199]
    ds_read_b64_tr_b16 v[42:43], v6 offset:512
    s_waitcnt lgkmcnt(10)
    v_mfma_f32_16x16x32_bf16 v[200:203], v[56:59], v[80:83], v[200:203]
    ds_read_b64_tr_b16 v[44:45], v7 offset:0
    v_mfma_f32_16x16x32_bf16 v[204:207], v[56:59], v[84:87], v[204:207]
    ds_read_b64_tr_b16 v[46:47], v7 offset:512
    s_waitcnt lgkmcnt(10)
    v_mfma_f32_16x16x32_bf16 v[208:211], v[60:63], v[80:83], v[208:211]
    ds_read_b128 v[72:75], v9 offset:0
    ds_read_b128 v[76:79], v9 offset:2048
    v_mfma_f32_16x16x32_bf16 v[212:215], v[60:63], v[84:87], v[212:215]
    ds_read_b64_tr_b16 v[48:49], v160 offset:0
    v_mfma_f32_16x16x32_bf16 v[216:219], v[80:83], v[108:111], v[216:219]
    ds_read_b64_tr_b16 v[50:51], v160 offset:512
    v_mfma_f32_16x16x32_bf16 v[220:223], v[84:87], v[108:111], v[220:223]
    s_waitcnt lgkmcnt(10)
    v_mfma_f32_16x16x32_bf16 v[184:187], v[32:35], v[64:67], v[184:187]
    ds_read_b64_tr_b16 v[52:53], v161 offset:0
    v_mfma_f32_16x16x32_bf16 v[188:191], v[32:35], v[68:71], v[188:191]
    ds_read_b64_tr_b16 v[54:55], v161 offset:512
    v_mfma_f32_16x16x32_bf16 v[152:155], v[240:243], v[32:35], v[152:155]
    s_waitcnt lgkmcnt(10)
    v_mfma_f32_16x16x32_bf16 v[192:195], v[36:39], v[64:67], v[192:195]
    ds_read_b64_tr_b16 v[56:57], v162 offset:0
    v_mfma_f32_16x16x32_bf16 v[196:199], v[36:39], v[68:71], v[196:199]
    ds_read_b64_tr_b16 v[58:59], v162 offset:512
    v_mfma_f32_16x16x32_bf16 v[156:159], v[240:243], v[36:39], v[156:159]
    s_waitcnt lgkmcnt(10)
    v_mfma_f32_16x16x32_bf16 v[200:203], v[40:43], v[64:67], v[200:203]
    ds_read_b64_tr_b16 v[60:61], v163 offset:0
    v_mfma_f32_16x16x32_bf16 v[204:207], v[40:43], v[68:71], v[204:207]
    ds_read_b64_tr_b16 v[62:63], v163 offset:512
    s_barrier
    s_waitcnt lgkmcnt(10)
    v_mfma_f32_16x16x32_bf16 v[208:211], v[44:47], v[64:67], v[208:211]
    ds_read_b128 v[80:83], v8 offset:24576
    ds_read_b128 v[84:87], v8 offset:26624
    v_mfma_f32_16x16x32_bf16 v[212:215], v[44:47], v[68:71], v[212:215]
    ds_read_b64_tr_b16 v[32:33], v4 offset:24576
    v_mfma_f32_16x16x32_bf16 v[216:219], v[64:67], v[112:115], v[216:219]
    ds_read_b64_tr_b16 v[34:35], v4 offset:25088
    v_mfma_f32_16x16x32_bf16 v[220:223], v[68:71], v[112:115], v[220:223]
    s_waitcnt lgkmcnt(10)
    v_mfma_f32_16x16x32_bf16 v[184:187], v[48:51], v[72:75], v[184:187]
    ds_read_b64_tr_b16 v[36:37], v5 offset:24576
    v_mfma_f32_16x16x32_bf16 v[188:191], v[48:51], v[76:79], v[188:191]
    ds_read_b64_tr_b16 v[38:39], v5 offset:25088
    s_waitcnt lgkmcnt(10)
    v_mfma_f32_16x16x32_bf16 v[192:195], v[52:55], v[72:75], v[192:195]
    ds_read_b64_tr_b16 v[40:41], v6 offset:24576
    v_mfma_f32_16x16x32_bf16 v[196:199], v[52:55], v[76:79], v[196:199]
    ds_read_b64_tr_b16 v[42:43], v6 offset:25088
    s_waitcnt lgkmcnt(10)
    v_mfma_f32_16x16x32_bf16 v[200:203], v[56:59], v[72:75], v[200:203]
    ds_read_b64_tr_b16 v[44:45], v7 offset:24576
    v_mfma_f32_16x16x32_bf16 v[204:207], v[56:59], v[76:79], v[204:207]
    ds_read_b64_tr_b16 v[46:47], v7 offset:25088
    s_waitcnt lgkmcnt(10)
    v_mfma_f32_16x16x32_bf16 v[208:211], v[60:63], v[72:75], v[208:211]
    ds_read_b128 v[64:67], v9 offset:24576
    ds_read_b128 v[68:71], v9 offset:26624
    v_mfma_f32_16x16x32_bf16 v[212:215], v[60:63], v[76:79], v[212:215]
    ds_read_b64_tr_b16 v[48:49], v160 offset:24576
    v_mfma_f32_16x16x32_bf16 v[216:219], v[72:75], v[116:119], v[216:219]
    ds_read_b64_tr_b16 v[50:51], v160 offset:25088
    v_mfma_f32_16x16x32_bf16 v[220:223], v[76:79], v[116:119], v[220:223]
    s_waitcnt lgkmcnt(10)
    v_mfma_f32_16x16x32_bf16 v[184:187], v[32:35], v[80:83], v[184:187]
    ds_read_b64_tr_b16 v[52:53], v161 offset:24576
    v_mfma_f32_16x16x32_bf16 v[188:191], v[32:35], v[84:87], v[188:191]
    ds_read_b64_tr_b16 v[54:55], v161 offset:25088
    v_mfma_f32_16x16x32_bf16 v[152:155], v[240:243], v[32:35], v[152:155]
    s_waitcnt lgkmcnt(10)
    v_mfma_f32_16x16x32_bf16 v[192:195], v[36:39], v[80:83], v[192:195]
    ds_read_b64_tr_b16 v[56:57], v162 offset:24576
    v_mfma_f32_16x16x32_bf16 v[196:199], v[36:39], v[84:87], v[196:199]
    ds_read_b64_tr_b16 v[58:59], v162 offset:25088
    v_mfma_f32_16x16x32_bf16 v[156:159], v[240:243], v[36:39], v[156:159]
    s_waitcnt lgkmcnt(10)
    v_mfma_f32_16x16x32_bf16 v[200:203], v[40:43], v[80:83], v[200:203]
    ds_read_b64_tr_b16 v[60:61], v163 offset:24576
    v_mfma_f32_16x16x32_bf16 v[204:207], v[40:43], v[84:87], v[204:207]
    ds_read_b64_tr_b16 v[62:63], v163 offset:25088
    v_subrev_u32 v4, 73728, v4
    v_subrev_u32 v5, 73728, v5
    v_subrev_u32 v6, 73728, v6
    v_subrev_u32 v7, 73728, v7
    v_subrev_u32 v8, 73728, v8
    v_subrev_u32 v9, 73728, v9
    v_subrev_u32 v160, 73728, v160
    v_subrev_u32 v161, 73728, v161
    v_subrev_u32 v162, 73728, v162
    v_subrev_u32 v163, 73728, v163
    s_barrier
    s_waitcnt lgkmcnt(10)
    v_mfma_f32_16x16x32_bf16 v[208:211], v[44:47], v[80:83], v[208:211]
    ds_read_b128 v[72:75], v8 offset:0
    ds_read_b128 v[76:79], v8 offset:2048
    v_mfma_f32_16x16x32_bf16 v[212:215], v[44:47], v[84:87], v[212:215]
    ds_read_b64_tr_b16 v[32:33], v4 offset:0
    v_mfma_f32_16x16x32_bf16 v[216:219], v[80:83], v[120:123], v[216:219]
    ds_read_b64_tr_b16 v[34:35], v4 offset:512
    v_mfma_f32_16x16x32_bf16 v[220:223], v[84:87], v[120:123], v[220:223]
    s_waitcnt lgkmcnt(10)
    v_mfma_f32_16x16x32_bf16 v[184:187], v[48:51], v[64:67], v[184:187]
    ds_read_b64_tr_b16 v[36:37], v5 offset:0
    v_mfma_f32_16x16x32_bf16 v[188:191], v[48:51], v[68:71], v[188:191]
    ds_read_b64_tr_b16 v[38:39], v5 offset:512
    s_waitcnt lgkmcnt(10)
    v_mfma_f32_16x16x32_bf16 v[192:195], v[52:55], v[64:67], v[192:195]
    ds_read_b64_tr_b16 v[40:41], v6 offset:0
    v_mfma_f32_16x16x32_bf16 v[196:199], v[52:55], v[68:71], v[196:199]
    ds_read_b64_tr_b16 v[42:43], v6 offset:512
    s_waitcnt lgkmcnt(10)
    v_mfma_f32_16x16x32_bf16 v[200:203], v[56:59], v[64:67], v[200:203]
    ds_read_b64_tr_b16 v[44:45], v7 offset:0
    v_mfma_f32_16x16x32_bf16 v[204:207], v[56:59], v[68:71], v[204:207]
    ds_read_b64_tr_b16 v[46:47], v7 offset:512
    s_waitcnt lgkmcnt(10)
    v_mfma_f32_16x16x32_bf16 v[208:211], v[60:63], v[64:67], v[208:211]
    ds_read_b128 v[80:83], v9 offset:0
    ds_read_b128 v[84:87], v9 offset:2048
    v_mfma_f32_16x16x32_bf16 v[212:215], v[60:63], v[68:71], v[212:215]
    ds_read_b64_tr_b16 v[48:49], v160 offset:0
    v_mfma_f32_16x16x32_bf16 v[216:219], v[64:67], v[124:127], v[216:219]
    ds_read_b64_tr_b16 v[50:51], v160 offset:512
    v_mfma_f32_16x16x32_bf16 v[220:223], v[68:71], v[124:127], v[220:223]
    s_waitcnt lgkmcnt(10)
    v_mfma_f32_16x16x32_bf16 v[184:187], v[32:35], v[72:75], v[184:187]
    ds_read_b64_tr_b16 v[52:53], v161 offset:0
    v_mfma_f32_16x16x32_bf16 v[188:191], v[32:35], v[76:79], v[188:191]
    ds_read_b64_tr_b16 v[54:55], v161 offset:512
    v_mfma_f32_16x16x32_bf16 v[152:155], v[240:243], v[32:35], v[152:155]
    s_waitcnt lgkmcnt(10)
    v_mfma_f32_16x16x32_bf16 v[192:195], v[36:39], v[72:75], v[192:195]
    ds_read_b64_tr_b16 v[56:57], v162 offset:0
    v_mfma_f32_16x16x32_bf16 v[196:199], v[36:39], v[76:79], v[196:199]
    ds_read_b64_tr_b16 v[58:59], v162 offset:512
    v_mfma_f32_16x16x32_bf16 v[156:159], v[240:243], v[36:39], v[156:159]
    s_waitcnt lgkmcnt(10)
    v_mfma_f32_16x16x32_bf16 v[200:203], v[40:43], v[72:75], v[200:203]
    ds_read_b64_tr_b16 v[60:61], v163 offset:0
    v_mfma_f32_16x16x32_bf16 v[204:207], v[40:43], v[76:79], v[204:207]
    ds_read_b64_tr_b16 v[62:63], v163 offset:512
    s_barrier
    s_waitcnt lgkmcnt(10)
    v_mfma_f32_16x16x32_bf16 v[208:211], v[44:47], v[72:75], v[208:211]
    ds_read_b128 v[64:67], v8 offset:24576
    ds_read_b128 v[68:71], v8 offset:26624
    v_mfma_f32_16x16x32_bf16 v[212:215], v[44:47], v[76:79], v[212:215]
    ds_read_b64_tr_b16 v[32:33], v4 offset:24576
    v_mfma_f32_16x16x32_bf16 v[216:219], v[72:75], v[128:131], v[216:219]
    ds_read_b64_tr_b16 v[34:35], v4 offset:25088
    v_mfma_f32_16x16x32_bf16 v[220:223], v[76:79], v[128:131], v[220:223]
    s_waitcnt lgkmcnt(10)
    v_mfma_f32_16x16x32_bf16 v[184:187], v[48:51], v[80:83], v[184:187]
    ds_read_b64_tr_b16 v[36:37], v5 offset:24576
    v_mfma_f32_16x16x32_bf16 v[188:191], v[48:51], v[84:87], v[188:191]
    ds_read_b64_tr_b16 v[38:39], v5 offset:25088
    s_waitcnt lgkmcnt(10)
    v_mfma_f32_16x16x32_bf16 v[192:195], v[52:55], v[80:83], v[192:195]
    ds_read_b64_tr_b16 v[40:41], v6 offset:24576
    v_mfma_f32_16x16x32_bf16 v[196:199], v[52:55], v[84:87], v[196:199]
    ds_read_b64_tr_b16 v[42:43], v6 offset:25088
    s_waitcnt lgkmcnt(10)
    v_mfma_f32_16x16x32_bf16 v[200:203], v[56:59], v[80:83], v[200:203]
    ds_read_b64_tr_b16 v[44:45], v7 offset:24576
    v_mfma_f32_16x16x32_bf16 v[204:207], v[56:59], v[84:87], v[204:207]
    ds_read_b64_tr_b16 v[46:47], v7 offset:25088
    s_waitcnt lgkmcnt(10)
    v_mfma_f32_16x16x32_bf16 v[208:211], v[60:63], v[80:83], v[208:211]
    ds_read_b128 v[72:75], v9 offset:24576
    ds_read_b128 v[76:79], v9 offset:26624
    v_mfma_f32_16x16x32_bf16 v[212:215], v[60:63], v[84:87], v[212:215]
    ds_read_b64_tr_b16 v[48:49], v160 offset:24576
    v_mfma_f32_16x16x32_bf16 v[216:219], v[80:83], v[132:135], v[216:219]
    ds_read_b64_tr_b16 v[50:51], v160 offset:25088
    v_mfma_f32_16x16x32_bf16 v[220:223], v[84:87], v[132:135], v[220:223]
    s_waitcnt lgkmcnt(10)
    v_mfma_f32_16x16x32_bf16 v[184:187], v[32:35], v[64:67], v[184:187]
    ds_read_b64_tr_b16 v[52:53], v161 offset:24576
    v_mfma_f32_16x16x32_bf16 v[188:191], v[32:35], v[68:71], v[188:191]
    ds_read_b64_tr_b16 v[54:55], v161 offset:25088
    v_mfma_f32_16x16x32_bf16 v[152:155], v[240:243], v[32:35], v[152:155]
    s_waitcnt lgkmcnt(10)
    v_mfma_f32_16x16x32_bf16 v[192:195], v[36:39], v[64:67], v[192:195]
    ds_read_b64_tr_b16 v[56:57], v162 offset:24576
    v_mfma_f32_16x16x32_bf16 v[196:199], v[36:39], v[68:71], v[196:199]
    ds_read_b64_tr_b16 v[58:59], v162 offset:25088
    v_mfma_f32_16x16x32_bf16 v[156:159], v[240:243], v[36:39], v[156:159]
    s_waitcnt lgkmcnt(10)
    v_mfma_f32_16x16x32_bf16 v[200:203], v[40:43], v[64:67], v[200:203]
    ds_read_b64_tr_b16 v[60:61], v163 offset:24576
    v_mfma_f32_16x16x32_bf16 v[204:207], v[40:43], v[68:71], v[204:207]
    ds_read_b64_tr_b16 v[62:63], v163 offset:25088
    s_barrier
    s_waitcnt lgkmcnt(10)
    v_mfma_f32_16x16x32_bf16 v[208:211], v[44:47], v[64:67], v[208:211]
    ds_read_b128 v[80:83], v8 offset:49152
    ds_read_b128 v[84:87], v8 offset:51200
    v_mfma_f32_16x16x32_bf16 v[212:215], v[44:47], v[68:71], v[212:215]
    ds_read_b64_tr_b16 v[32:33], v4 offset:49152
    v_mfma_f32_16x16x32_bf16 v[216:219], v[64:67], v[136:139], v[216:219]
    ds_read_b64_tr_b16 v[34:35], v4 offset:49664
    v_mfma_f32_16x16x32_bf16 v[220:223], v[68:71], v[136:139], v[220:223]
    s_waitcnt lgkmcnt(10)
    v_mfma_f32_16x16x32_bf16 v[184:187], v[48:51], v[72:75], v[184:187]
    ds_read_b64_tr_b16 v[36:37], v5 offset:49152
    v_mfma_f32_16x16x32_bf16 v[188:191], v[48:51], v[76:79], v[188:191]
    ds_read_b64_tr_b16 v[38:39], v5 offset:49664
    s_waitcnt lgkmcnt(10)
    v_mfma_f32_16x16x32_bf16 v[192:195], v[52:55], v[72:75], v[192:195]
    ds_read_b64_tr_b16 v[40:41], v6 offset:49152
    v_mfma_f32_16x16x32_bf16 v[196:199], v[52:55], v[76:79], v[196:199]
    ds_read_b64_tr_b16 v[42:43], v6 offset:49664
    s_waitcnt lgkmcnt(10)
    v_mfma_f32_16x16x32_bf16 v[200:203], v[56:59], v[72:75], v[200:203]
    ds_read_b64_tr_b16 v[44:45], v7 offset:49152
    v_mfma_f32_16x16x32_bf16 v[204:207], v[56:59], v[76:79], v[204:207]
    ds_read_b64_tr_b16 v[46:47], v7 offset:49664
    s_waitcnt lgkmcnt(10)
    v_mfma_f32_16x16x32_bf16 v[208:211], v[60:63], v[72:75], v[208:211]
    ds_read_b128 v[64:67], v9 offset:49152
    ds_read_b128 v[68:71], v9 offset:51200
    v_mfma_f32_16x16x32_bf16 v[212:215], v[60:63], v[76:79], v[212:215]
    ds_read_b64_tr_b16 v[48:49], v160 offset:49152
    v_mfma_f32_16x16x32_bf16 v[216:219], v[72:75], v[140:143], v[216:219]
    ds_read_b64_tr_b16 v[50:51], v160 offset:49664
    v_mfma_f32_16x16x32_bf16 v[220:223], v[76:79], v[140:143], v[220:223]
    s_waitcnt lgkmcnt(10)
    v_mfma_f32_16x16x32_bf16 v[184:187], v[32:35], v[80:83], v[184:187]
    ds_read_b64_tr_b16 v[52:53], v161 offset:49152
    v_mfma_f32_16x16x32_bf16 v[188:191], v[32:35], v[84:87], v[188:191]
    ds_read_b64_tr_b16 v[54:55], v161 offset:49664
    v_mfma_f32_16x16x32_bf16 v[152:155], v[240:243], v[32:35], v[152:155]
    s_waitcnt lgkmcnt(10)
    v_mfma_f32_16x16x32_bf16 v[192:195], v[36:39], v[80:83], v[192:195]
    ds_read_b64_tr_b16 v[56:57], v162 offset:49152
    v_mfma_f32_16x16x32_bf16 v[196:199], v[36:39], v[84:87], v[196:199]
    ds_read_b64_tr_b16 v[58:59], v162 offset:49664
    v_mfma_f32_16x16x32_bf16 v[156:159], v[240:243], v[36:39], v[156:159]
    s_waitcnt lgkmcnt(10)
    v_mfma_f32_16x16x32_bf16 v[200:203], v[40:43], v[80:83], v[200:203]
    ds_read_b64_tr_b16 v[60:61], v163 offset:49152
    v_mfma_f32_16x16x32_bf16 v[204:207], v[40:43], v[84:87], v[204:207]
    ds_read_b64_tr_b16 v[62:63], v163 offset:49664
    s_waitcnt lgkmcnt(10)
    v_mfma_f32_16x16x32_bf16 v[208:211], v[44:47], v[80:83], v[208:211]
    v_mfma_f32_16x16x32_bf16 v[212:215], v[44:47], v[84:87], v[212:215]
    v_mfma_f32_16x16x32_bf16 v[216:219], v[80:83], v[144:147], v[216:219]
    v_mfma_f32_16x16x32_bf16 v[220:223], v[84:87], v[144:147], v[220:223]
    s_waitcnt lgkmcnt(6)
    v_mfma_f32_16x16x32_bf16 v[184:187], v[48:51], v[64:67], v[184:187]
    v_mfma_f32_16x16x32_bf16 v[188:191], v[48:51], v[68:71], v[188:191]
    s_waitcnt lgkmcnt(4)
    v_mfma_f32_16x16x32_bf16 v[192:195], v[52:55], v[64:67], v[192:195]
    v_mfma_f32_16x16x32_bf16 v[196:199], v[52:55], v[68:71], v[196:199]
    s_waitcnt lgkmcnt(2)
    v_mfma_f32_16x16x32_bf16 v[200:203], v[56:59], v[64:67], v[200:203]
    v_mfma_f32_16x16x32_bf16 v[204:207], v[56:59], v[68:71], v[204:207]
    s_waitcnt lgkmcnt(0)
    v_mfma_f32_16x16x32_bf16 v[208:211], v[60:63], v[64:67], v[208:211]
    v_mfma_f32_16x16x32_bf16 v[212:215], v[60:63], v[68:71], v[212:215]
    v_mfma_f32_16x16x32_bf16 v[216:219], v[64:67], v[148:151], v[216:219]
    v_mfma_f32_16x16x32_bf16 v[220:223], v[68:71], v[148:151], v[220:223]
    v_add_u32 v17, s63, v15
    s_mov_b64 exec, 0xffff
    ds_add_f32 v10, v152 offset:0
    ds_add_f32 v10, v156 offset:64
    s_mov_b64 exec, -1
    s_waitcnt lgkmcnt(0)
    s_barrier
    ds_read_b32 v24, v17 offset:512
    ds_read_b32 v26, v17 offset:1024
    ds_read_b32 v28, v17 offset:576
    ds_read_b32 v30, v17 offset:1088
    v_xor_b32 v22, s79, v12
    ds_read_b128 v[240:243], v22 offset:0
    ds_read_b128 v[248:251], v22 offset:1536
    ds_read_b128 v[244:247], v22 offset:64
    ds_read_b128 v[252:255], v22 offset:1600
    v_xor_b32 v23, 0x80, v22
    ds_read_b128 v[224:227], v23 offset:0
    ds_read_b128 v[232:235], v23 offset:1536
    ds_read_b128 v[228:231], v23 offset:64
    ds_read_b128 v[236:239], v23 offset:1600
    v_add_u32 v20, s63, v12
    ds_read_b128 v[92:95], v20 offset:1024
    ds_read_b128 v[100:103], v20 offset:1088
    s_waitcnt lgkmcnt(6)
    v_mul_f32 v24, v24, v26
    v_mul_f32 v28, v28, v30
    v_pk_fma_f32 v[32:33], v[24:25], v[240:241], v[248:249] op_sel_hi:[0,1,1] neg_lo:[1,0,0] neg_hi:[1,0,0]
    v_pk_fma_f32 v[34:35], v[24:25], v[242:243], v[250:251] op_sel_hi:[0,1,1] neg_lo:[1,0,0] neg_hi:[1,0,0]
    v_pk_fma_f32 v[36:37], v[24:25], v[244:245], v[252:253] op_sel_hi:[0,1,1] neg_lo:[1,0,0] neg_hi:[1,0,0]
    v_pk_fma_f32 v[38:39], v[24:25], v[246:247], v[254:255] op_sel_hi:[0,1,1] neg_lo:[1,0,0] neg_hi:[1,0,0]
    v_pk_fma_f32 v[32:33], v[26:27], v[184:185], v[32:33] op_sel_hi:[0,1,1]
    v_pk_fma_f32 v[34:35], v[26:27], v[186:187], v[34:35] op_sel_hi:[0,1,1]
    v_pk_fma_f32 v[36:37], v[26:27], v[192:193], v[36:37] op_sel_hi:[0,1,1]
    v_pk_fma_f32 v[38:39], v[26:27], v[194:195], v[38:39] op_sel_hi:[0,1,1]
    v_mul_f32 v32, v32, |v32|
    v_mul_f32 v33, v33, |v33|
    v_mul_f32 v34, v34, |v34|
    v_mul_f32 v35, v35, |v35|
    v_mul_f32 v36, v36, |v36|
    v_mul_f32 v37, v37, |v37|
    v_mul_f32 v38, v38, |v38|
    v_mul_f32 v39, v39, |v39|
    v_cvt_pk_bf16_f32 v40, v32, v33
    v_cvt_pk_bf16_f32 v41, v34, v35
    v_cvt_pk_bf16_f32 v42, v36, v37
    v_cvt_pk_bf16_f32 v43, v38, v39
    v_pk_max_i16 v40, v40, 0
    v_pk_max_i16 v41, v41, 0
    v_pk_max_i16 v42, v42, 0
    v_pk_max_i16 v43, v43, 0
    buffer_store_dwordx4 v[40:43], v11, s[36:39], s60 offen sc1
    v_pk_fma_f32 v[44:45], v[28:29], v[240:241], v[248:249] op_sel_hi:[0,1,1] neg_lo:[1,0,0] neg_hi:[1,0,0]
    v_pk_fma_f32 v[46:47], v[28:29], v[242:243], v[250:251] op_sel_hi:[0,1,1] neg_lo:[1,0,0] neg_hi:[1,0,0]
    v_pk_fma_f32 v[48:49], v[28:29], v[244:245], v[252:253] op_sel_hi:[0,1,1] neg_lo:[1,0,0] neg_hi:[1,0,0]
    v_pk_fma_f32 v[50:51], v[28:29], v[246:247], v[254:255] op_sel_hi:[0,1,1] neg_lo:[1,0,0] neg_hi:[1,0,0]
    v_pk_fma_f32 v[44:45], v[30:31], v[188:189], v[44:45] op_sel_hi:[0,1,1]
    v_pk_fma_f32 v[46:47], v[30:31], v[190:191], v[46:47] op_sel_hi:[0,1,1]
    v_pk_fma_f32 v[48:49], v[30:31], v[196:197], v[48:49] op_sel_hi:[0,1,1]
    v_pk_fma_f32 v[50:51], v[30:31], v[198:199], v[50:51] op_sel_hi:[0,1,1]
    v_mul_f32 v44, v44, |v44|
    v_mul_f32 v45, v45, |v45|
    v_mul_f32 v46, v46, |v46|
    v_mul_f32 v47, v47, |v47|
    v_mul_f32 v48, v48, |v48|
    v_mul_f32 v49, v49, |v49|
    v_mul_f32 v50, v50, |v50|
    v_mul_f32 v51, v51, |v51|
    v_cvt_pk_bf16_f32 v52, v44, v45
    v_cvt_pk_bf16_f32 v53, v46, v47
    v_cvt_pk_bf16_f32 v54, v48, v49
    v_cvt_pk_bf16_f32 v55, v50, v51
    v_pk_max_i16 v52, v52, 0
    v_pk_max_i16 v53, v53, 0
    v_pk_max_i16 v54, v54, 0
    v_pk_max_i16 v55, v55, 0
    buffer_store_dwordx4 v[52:55], v11, s[36:39], s61 offen sc1
    s_waitcnt lgkmcnt(0)
    s_add_u32 s60, s60, s65
    s_add_u32 s61, s61, s65
    v_pk_fma_f32 v[64:65], v[24:25], v[224:225], v[232:233] op_sel_hi:[0,1,1] neg_lo:[1,0,0] neg_hi:[1,0,0]
    v_pk_fma_f32 v[66:67], v[24:25], v[226:227], v[234:235] op_sel_hi:[0,1,1] neg_lo:[1,0,0] neg_hi:[1,0,0]
    v_pk_fma_f32 v[68:69], v[24:25], v[228:229], v[236:237] op_sel_hi:[0,1,1] neg_lo:[1,0,0] neg_hi:[1,0,0]
    v_pk_fma_f32 v[70:71], v[24:25], v[230:231], v[238:239] op_sel_hi:[0,1,1] neg_lo:[1,0,0] neg_hi:[1,0,0]
    v_pk_fma_f32 v[64:65], v[26:27], v[200:201], v[64:65] op_sel_hi:[0,1,1]
    v_pk_fma_f32 v[66:67], v[26:27], v[202:203], v[66:67] op_sel_hi:[0,1,1]
    v_pk_fma_f32 v[68:69], v[26:27], v[208:209], v[68:69] op_sel_hi:[0,1,1]
    v_pk_fma_f32 v[70:71], v[26:27], v[210:211], v[70:71] op_sel_hi:[0,1,1]
    v_mul_f32 v64, v64, |v64|
    v_mul_f32 v65, v65, |v65|
    v_mul_f32 v66, v66, |v66|
    v_mul_f32 v67, v67, |v67|
    v_mul_f32 v68, v68, |v68|
    v_mul_f32 v69, v69, |v69|
    v_mul_f32 v70, v70, |v70|
    v_mul_f32 v71, v71, |v71|
    v_cvt_pk_bf16_f32 v72, v64, v65
    v_cvt_pk_bf16_f32 v73, v66, v67
    v_cvt_pk_bf16_f32 v74, v68, v69
    v_cvt_pk_bf16_f32 v75, v70, v71
    v_pk_max_i16 v72, v72, 0
    v_pk_max_i16 v73, v73, 0
    v_pk_max_i16 v74, v74, 0
    v_pk_max_i16 v75, v75, 0
    buffer_store_dwordx4 v[72:75], v11, s[36:39], s60 offen sc1
    v_pk_fma_f32 v[76:77], v[28:29], v[224:225], v[232:233] op_sel_hi:[0,1,1] neg_lo:[1,0,0] neg_hi:[1,0,0]
    v_pk_fma_f32 v[78:79], v[28:29], v[226:227], v[234:235] op_sel_hi:[0,1,1] neg_lo:[1,0,0] neg_hi:[1,0,0]
    v_pk_fma_f32 v[80:81], v[28:29], v[228:229], v[236:237] op_sel_hi:[0,1,1] neg_lo:[1,0,0] neg_hi:[1,0,0]
    v_pk_fma_f32 v[82:83], v[28:29], v[230:231], v[238:239] op_sel_hi:[0,1,1] neg_lo:[1,0,0] neg_hi:[1,0,0]
    v_pk_fma_f32 v[76:77], v[30:31], v[204:205], v[76:77] op_sel_hi:[0,1,1]
    v_pk_fma_f32 v[78:79], v[30:31], v[206:207], v[78:79] op_sel_hi:[0,1,1]
    v_pk_fma_f32 v[80:81], v[30:31], v[212:213], v[80:81] op_sel_hi:[0,1,1]
    v_pk_fma_f32 v[82:83], v[30:31], v[214:215], v[82:83] op_sel_hi:[0,1,1]
    v_mul_f32 v76, v76, |v76|
    v_mul_f32 v77, v77, |v77|
    v_mul_f32 v78, v78, |v78|
    v_mul_f32 v79, v79, |v79|
    v_mul_f32 v80, v80, |v80|
    v_mul_f32 v81, v81, |v81|
    v_mul_f32 v82, v82, |v82|
    v_mul_f32 v83, v83, |v83|
    v_cvt_pk_bf16_f32 v84, v76, v77
    v_cvt_pk_bf16_f32 v85, v78, v79
    v_cvt_pk_bf16_f32 v86, v80, v81
    v_cvt_pk_bf16_f32 v87, v82, v83
    v_pk_max_i16 v84, v84, 0
    v_pk_max_i16 v85, v85, 0
    v_pk_max_i16 v86, v86, 0
    v_pk_max_i16 v87, v87, 0
    buffer_store_dwordx4 v[84:87], v11, s[36:39], s61 offen sc1
    v_lshl_add_u32 v16, s53, 4, v2
    v_cmp_eq_u32 vcc, 0, v16
    s_lshl_b32 s66, s53, 14
    s_add_u32 s66, s66, 0xcc000
    v_mov_b32 v18, 0x44000
    v_mul_lo_u32 v18, v18, v3
    v_sub_u32 v17, s66, v18
    v_add_u32 v18, 0x40000, v18
    v_cndmask_b32 v17, v17, v18, vcc
    v_lshl_add_u32 v17, v2, 4, v17
    v_mov_b32 v18, -1.0
    v_cndmask_b32 v18, v18, 1.0, vcc
    v_add_u32 v22, 288, v16
    v_mov_b32 v23, 0x100
    v_cndmask_b32 v22, v22, v23, vcc
    v_lshlrev_b32 v22, 2, v22
    v_add_u32 v22, 0xb10000, v22
    v_mul_f32 v108, v216, v92
    v_mul_f32 v109, v217, v93
    v_mul_f32 v110, v218, v94
    v_mul_f32 v111, v219, v95
    v_fma_f32 v112, v18, v109, v108
    v_fma_f32 v113, v18, v111, v110
    v_add_f32 v104, v112, v113
    v_sub_f32 v106, v112, v113
    v_sub_f32 v114, v108, v109
    v_cndmask_b32 v114, 0, v114, vcc
    v_cndmask_b32 v115, 0, v112, vcc
    v_cndmask_b32 v104, v104, v115, s[76:77]
    v_cndmask_b32 v106, v106, v114, s[76:77]
    s_cmp_eq_u32 s76, 0
    s_cbranch_scc1 K1_NOX_F_g
    s_mov_b64 exec, s[76:77]
    buffer_store_dword v113, v22, s[36:39], 0 offen
    s_mov_b64 exec, -1
K1_NOX_F_g:
    v_mul_f32 v108, v220, v100
    v_mul_f32 v109, v221, v101
    v_mul_f32 v110, v222, v102
    v_mul_f32 v111, v223, v103
    v_fma_f32 v112, v18, v109, v108
    v_fma_f32 v113, v18, v111, v110
    v_add_f32 v105, v112, v113
    v_sub_f32 v107, v112, v113
    v_cvt_pk_bf16_f32 v116, v104, v105
    v_cvt_pk_bf16_f32 v117, v106, v107
    s_nop 1
    v_permlane32_swap_b32 v116, v118
    v_permlane32_swap_b32 v117, v119
    s_nop 1
    v_permlane16_swap_b32 v116, v117
    v_permlane16_swap_b32 v118, v119
    s_mov_b32 exec_hi, 0
    buffer_store_dwordx4 v[116:119], v17, s[36:39], s64 offen sc1
    s_mov_b32 exec_hi, -1
    s_endpgm
K1_PB_F:
    ds_read_b64_tr_b16 v[32:33], v4 offset:0
    ds_read_b64_tr_b16 v[34:35], v4 offset:512
    ds_read_b64_tr_b16 v[36:37], v5 offset:0
    ds_read_b64_tr_b16 v[38:39], v5 offset:512
    ds_read_b64_tr_b16 v[40:41], v6 offset:0
    ds_read_b64_tr_b16 v[42:43], v6 offset:512
    ds_read_b64_tr_b16 v[44:45], v7 offset:0
    ds_read_b64_tr_b16 v[46:47], v7 offset:512
    ds_read_b64_tr_b16 v[48:49], v224 offset:0
    ds_read_b64_tr_b16 v[50:51], v224 offset:512
    ds_read_b64_tr_b16 v[52:53], v225 offset:0
    ds_read_b64_tr_b16 v[54:55], v225 offset:512
    ds_read_b64_tr_b16 v[228:229], v226 offset:0
    ds_read_b64_tr_b16 v[230:231], v226 offset:512
    s_waitcnt lgkmcnt(12)
    v_mfma_f32_16x16x32_bf16 v[184:187], v[32:35], v[56:59], 0
    ds_read_b64_tr_b16 v[232:233], v227 offset:0
    v_mfma_f32_16x16x32_bf16 v[188:191], v[32:35], v[60:63], 0
    ds_read_b64_tr_b16 v[234:235], v227 offset:512
    v_mfma_f32_16x16x32_bf16 v[216:219], v[240:243], v[32:35], 0
    s_waitcnt lgkmcnt(12)
    v_mfma_f32_16x16x32_bf16 v[192:195], v[36:39], v[56:59], 0
    ds_read_b64_tr_b16 v[236:237], v4 offset:8192
    v_mfma_f32_16x16x32_bf16 v[196:199], v[36:39], v[60:63], 0
    ds_read_b64_tr_b16 v[238:239], v4 offset:8704
    v_mfma_f32_16x16x32_bf16 v[220:223], v[240:243], v[36:39], 0
    s_waitcnt lgkmcnt(12)
    v_mfma_f32_16x16x32_bf16 v[200:203], v[40:43], v[56:59], 0
    ds_read_b64_tr_b16 v[32:33], v5 offset:8192
    v_mfma_f32_16x16x32_bf16 v[204:207], v[40:43], v[60:63], 0
    ds_read_b64_tr_b16 v[34:35], v5 offset:8704
    s_waitcnt lgkmcnt(12)
    v_mfma_f32_16x16x32_bf16 v[208:211], v[44:47], v[56:59], 0
    ds_read_b64_tr_b16 v[36:37], v6 offset:8192
    v_mfma_f32_16x16x32_bf16 v[212:215], v[44:47], v[60:63], 0
    ds_read_b64_tr_b16 v[38:39], v6 offset:8704
    s_waitcnt lgkmcnt(12)
    v_mfma_f32_16x16x32_bf16 v[184:187], v[48:51], v[64:67], v[184:187]
    ds_read_b64_tr_b16 v[40:41], v7 offset:8192
    v_mfma_f32_16x16x32_bf16 v[188:191], v[48:51], v[68:71], v[188:191]
    ds_read_b64_tr_b16 v[42:43], v7 offset:8704
    s_waitcnt lgkmcnt(12)
    v_mfma_f32_16x16x32_bf16 v[192:195], v[52:55], v[64:67], v[192:195]
    ds_read_b64_tr_b16 v[44:45], v224 offset:8192
    v_mfma_f32_16x16x32_bf16 v[196:199], v[52:55], v[68:71], v[196:199]
    ds_read_b64_tr_b16 v[46:47], v224 offset:8704
    s_waitcnt lgkmcnt(12)
    v_mfma_f32_16x16x32_bf16 v[200:203], v[228:231], v[64:67], v[200:203]
    ds_read_b64_tr_b16 v[48:49], v225 offset:8192
    v_mfma_f32_16x16x32_bf16 v[204:207], v[228:231], v[68:71], v[204:207]
    ds_read_b64_tr_b16 v[50:51], v225 offset:8704
    s_waitcnt lgkmcnt(12)
    v_mfma_f32_16x16x32_bf16 v[208:211], v[232:235], v[64:67], v[208:211]
    ds_read_b64_tr_b16 v[52:53], v226 offset:8192
    v_mfma_f32_16x16x32_bf16 v[212:215], v[232:235], v[68:71], v[212:215]
    ds_read_b64_tr_b16 v[54:55], v226 offset:8704
    s_waitcnt lgkmcnt(12)
    v_mfma_f32_16x16x32_bf16 v[184:187], v[236:239], v[72:75], v[184:187]
    ds_read_b64_tr_b16 v[228:229], v227 offset:8192
    v_mfma_f32_16x16x32_bf16 v[188:191], v[236:239], v[76:79], v[188:191]
    ds_read_b64_tr_b16 v[230:231], v227 offset:8704
    v_mfma_f32_16x16x32_bf16 v[216:219], v[240:243], v[236:239], v[216:219]
    s_waitcnt lgkmcnt(12)
    v_mfma_f32_16x16x32_bf16 v[192:195], v[32:35], v[72:75], v[192:195]
    ds_read_b64_tr_b16 v[232:233], v4 offset:16384
    v_mfma_f32_16x16x32_bf16 v[196:199], v[32:35], v[76:79], v[196:199]
    ds_read_b64_tr_b16 v[234:235], v4 offset:16896
    v_mfma_f32_16x16x32_bf16 v[220:223], v[240:243], v[32:35], v[220:223]
    s_waitcnt lgkmcnt(12)
    v_mfma_f32_16x16x32_bf16 v[200:203], v[36:39], v[72:75], v[200:203]
    ds_read_b64_tr_b16 v[236:237], v5 offset:16384
    v_mfma_f32_16x16x32_bf16 v[204:207], v[36:39], v[76:79], v[204:207]
    ds_read_b64_tr_b16 v[238:239], v5 offset:16896
    s_waitcnt lgkmcnt(12)
    v_mfma_f32_16x16x32_bf16 v[208:211], v[40:43], v[72:75], v[208:211]
    ds_read_b64_tr_b16 v[32:33], v6 offset:16384
    v_mfma_f32_16x16x32_bf16 v[212:215], v[40:43], v[76:79], v[212:215]
    ds_read_b64_tr_b16 v[34:35], v6 offset:16896
    s_waitcnt lgkmcnt(12)
    v_mfma_f32_16x16x32_bf16 v[184:187], v[44:47], v[80:83], v[184:187]
    ds_read_b64_tr_b16 v[36:37], v7 offset:16384
    v_mfma_f32_16x16x32_bf16 v[188:191], v[44:47], v[84:87], v[188:191]
    ds_read_b64_tr_b16 v[38:39], v7 offset:16896
    s_waitcnt lgkmcnt(12)
    v_mfma_f32_16x16x32_bf16 v[192:195], v[48:51], v[80:83], v[192:195]
    ds_read_b64_tr_b16 v[40:41], v224 offset:16384
    v_mfma_f32_16x16x32_bf16 v[196:199], v[48:51], v[84:87], v[196:199]
    ds_read_b64_tr_b16 v[42:43], v224 offset:16896
    s_waitcnt lgkmcnt(12)
    v_mfma_f32_16x16x32_bf16 v[200:203], v[52:55], v[80:83], v[200:203]
    ds_read_b64_tr_b16 v[44:45], v225 offset:16384
    v_mfma_f32_16x16x32_bf16 v[204:207], v[52:55], v[84:87], v[204:207]
    ds_read_b64_tr_b16 v[46:47], v225 offset:16896
    s_waitcnt lgkmcnt(12)
    v_mfma_f32_16x16x32_bf16 v[208:211], v[228:231], v[80:83], v[208:211]
    ds_read_b64_tr_b16 v[48:49], v226 offset:16384
    v_mfma_f32_16x16x32_bf16 v[212:215], v[228:231], v[84:87], v[212:215]
    ds_read_b64_tr_b16 v[50:51], v226 offset:16896
    s_waitcnt lgkmcnt(12)
    v_mfma_f32_16x16x32_bf16 v[184:187], v[232:235], v[88:91], v[184:187]
    ds_read_b64_tr_b16 v[52:53], v227 offset:16384
    v_mfma_f32_16x16x32_bf16 v[188:191], v[232:235], v[92:95], v[188:191]
    ds_read_b64_tr_b16 v[54:55], v227 offset:16896
    v_mfma_f32_16x16x32_bf16 v[216:219], v[240:243], v[232:235], v[216:219]
    s_waitcnt lgkmcnt(12)
    v_mfma_f32_16x16x32_bf16 v[192:195], v[236:239], v[88:91], v[192:195]
    ds_read_b64_tr_b16 v[228:229], v4 offset:24576
    v_mfma_f32_16x16x32_bf16 v[196:199], v[236:239], v[92:95], v[196:199]
    ds_read_b64_tr_b16 v[230:231], v4 offset:25088
    v_mfma_f32_16x16x32_bf16 v[220:223], v[240:243], v[236:239], v[220:223]
    s_waitcnt lgkmcnt(12)
    s_waitcnt vmcnt(2)
    v_mov_b32 v18, 155648
    v_mov_b32 v19, 1
    s_mov_b64 exec, 1
    ds_add_u32 v18, v19 offset:2048
    s_mov_b64 exec, -1
    v_mfma_f32_16x16x32_bf16 v[200:203], v[32:35], v[88:91], v[200:203]
    ds_read_b64_tr_b16 v[232:233], v5 offset:24576
    v_mfma_f32_16x16x32_bf16 v[204:207], v[32:35], v[92:95], v[204:207]
    ds_read_b64_tr_b16 v[234:235], v5 offset:25088
    s_waitcnt lgkmcnt(13)
    v_mfma_f32_16x16x32_bf16 v[208:211], v[36:39], v[88:91], v[208:211]
    ds_read_b64_tr_b16 v[236:237], v6 offset:24576
    v_mfma_f32_16x16x32_bf16 v[212:215], v[36:39], v[92:95], v[212:215]
    ds_read_b64_tr_b16 v[238:239], v6 offset:25088
    s_waitcnt lgkmcnt(13)
    v_mfma_f32_16x16x32_bf16 v[184:187], v[40:43], v[96:99], v[184:187]
    ds_read_b64_tr_b16 v[32:33], v7 offset:24576
    v_mfma_f32_16x16x32_bf16 v[188:191], v[40:43], v[100:103], v[188:191]
    ds_read_b64_tr_b16 v[34:35], v7 offset:25088
    s_waitcnt lgkmcnt(13)
    v_mfma_f32_16x16x32_bf16 v[192:195], v[44:47], v[96:99], v[192:195]
    ds_read_b64_tr_b16 v[36:37], v224 offset:24576
    v_mfma_f32_16x16x32_bf16 v[196:199], v[44:47], v[100:103], v[196:199]
    ds_read_b64_tr_b16 v[38:39], v224 offset:25088
    s_waitcnt lgkmcnt(13)
    v_mfma_f32_16x16x32_bf16 v[200:203], v[48:51], v[96:99], v[200:203]
    ds_read_b64_tr_b16 v[40:41], v225 offset:24576
    v_mfma_f32_16x16x32_bf16 v[204:207], v[48:51], v[100:103], v[204:207]
    ds_read_b64_tr_b16 v[42:43], v225 offset:25088
    s_waitcnt lgkmcnt(13)
    v_mfma_f32_16x16x32_bf16 v[208:211], v[52:55], v[96:99], v[208:211]
    ds_read_b64_tr_b16 v[44:45], v226 offset:24576
    v_mfma_f32_16x16x32_bf16 v[212:215], v[52:55], v[100:103], v[212:215]
    ds_read_b64_tr_b16 v[46:47], v226 offset:25088
    s_waitcnt lgkmcnt(13)
    v_mfma_f32_16x16x32_bf16 v[184:187], v[228:231], v[104:107], v[184:187]
    ds_read_b64_tr_b16 v[48:49], v227 offset:24576
    v_mfma_f32_16x16x32_bf16 v[188:191], v[228:231], v[108:111], v[188:191]
    ds_read_b64_tr_b16 v[50:51], v227 offset:25088
    v_mfma_f32_16x16x32_bf16 v[216:219], v[240:243], v[228:231], v[216:219]
    v_subrev_u32 v4, 49152, v4
    v_subrev_u32 v5, 49152, v5
    v_subrev_u32 v6, 49152, v6
    v_subrev_u32 v7, 49152, v7
    v_subrev_u32 v224, 49152, v224
    v_subrev_u32 v225, 49152, v225
    v_subrev_u32 v226, 49152, v226
    v_subrev_u32 v227, 49152, v227
    s_waitcnt lgkmcnt(8)
K1_SPIN_F_0:
    ds_read_b32 v19, v18 offset:2048
    s_waitcnt lgkmcnt(0)
    v_readfirstlane_b32 s72, v19
    s_cmp_lt_u32 s72, 4
    s_cbranch_scc1 K1_SPIN_F_0
    v_mfma_f32_16x16x32_bf16 v[192:195], v[232:235], v[104:107], v[192:195]
    ds_read_b64_tr_b16 v[52:53], v4 offset:0
    v_mfma_f32_16x16x32_bf16 v[196:199], v[232:235], v[108:111], v[196:199]
    ds_read_b64_tr_b16 v[54:55], v4 offset:512
    v_mfma_f32_16x16x32_bf16 v[220:223], v[240:243], v[232:235], v[220:223]
    v_mfma_f32_16x16x32_bf16 v[200:203], v[236:239], v[104:107], v[200:203]
    ds_read_b64_tr_b16 v[228:229], v5 offset:0
    v_mfma_f32_16x16x32_bf16 v[204:207], v[236:239], v[108:111], v[204:207]
    ds_read_b64_tr_b16 v[230:231], v5 offset:512
    v_mfma_f32_16x16x32_bf16 v[208:211], v[32:35], v[104:107], v[208:211]
    ds_read_b64_tr_b16 v[232:233], v224 offset:0
    v_mfma_f32_16x16x32_bf16 v[212:215], v[32:35], v[108:111], v[212:215]
    ds_read_b64_tr_b16 v[234:235], v224 offset:512
    v_mfma_f32_16x16x32_bf16 v[184:187], v[36:39], v[112:115], v[184:187]
    ds_read_b64_tr_b16 v[236:237], v225 offset:0
    v_mfma_f32_16x16x32_bf16 v[188:191], v[36:39], v[116:119], v[188:191]
    ds_read_b64_tr_b16 v[238:239], v225 offset:512
    v_mfma_f32_16x16x32_bf16 v[192:195], v[40:43], v[112:115], v[192:195]
    ds_read_b64_tr_b16 v[32:33], v4 offset:8192
    v_mfma_f32_16x16x32_bf16 v[196:199], v[40:43], v[116:119], v[196:199]
    ds_read_b64_tr_b16 v[34:35], v4 offset:8704
    v_mfma_f32_16x16x32_bf16 v[200:203], v[44:47], v[112:115], v[200:203]
    ds_read_b64_tr_b16 v[36:37], v5 offset:8192
    v_mfma_f32_16x16x32_bf16 v[204:207], v[44:47], v[116:119], v[204:207]
    ds_read_b64_tr_b16 v[38:39], v5 offset:8704
    v_mfma_f32_16x16x32_bf16 v[208:211], v[48:51], v[112:115], v[208:211]
    ds_read_b64_tr_b16 v[40:41], v224 offset:8192
    v_mfma_f32_16x16x32_bf16 v[212:215], v[48:51], v[116:119], v[212:215]
    ds_read_b64_tr_b16 v[42:43], v224 offset:8704
    s_waitcnt lgkmcnt(12)
    v_mfma_f32_16x16x32_bf16 v[184:187], v[52:55], v[120:123], v[184:187]
    ds_read_b64_tr_b16 v[44:45], v225 offset:8192
    v_mfma_f32_16x16x32_bf16 v[188:191], v[52:55], v[124:127], v[188:191]
    ds_read_b64_tr_b16 v[46:47], v225 offset:8704
    v_mfma_f32_16x16x32_bf16 v[216:219], v[240:243], v[52:55], v[216:219]
    s_waitcnt lgkmcnt(12)
    v_mfma_f32_16x16x32_bf16 v[192:195], v[228:231], v[120:123], v[192:195]
    ds_read_b64_tr_b16 v[48:49], v4 offset:16384
    v_mfma_f32_16x16x32_bf16 v[196:199], v[228:231], v[124:127], v[196:199]
    ds_read_b64_tr_b16 v[50:51], v4 offset:16896
    v_mfma_f32_16x16x32_bf16 v[220:223], v[240:243], v[228:231], v[220:223]
    s_waitcnt lgkmcnt(12)
    v_mfma_f32_16x16x32_bf16 v[184:187], v[232:235], v[128:131], v[184:187]
    ds_read_b64_tr_b16 v[52:53], v5 offset:16384
    v_mfma_f32_16x16x32_bf16 v[188:191], v[232:235], v[132:135], v[188:191]
    ds_read_b64_tr_b16 v[54:55], v5 offset:16896
    s_waitcnt lgkmcnt(12)
    v_mfma_f32_16x16x32_bf16 v[192:195], v[236:239], v[128:131], v[192:195]
    ds_read_b64_tr_b16 v[228:229], v224 offset:16384
    v_mfma_f32_16x16x32_bf16 v[196:199], v[236:239], v[132:135], v[196:199]
    ds_read_b64_tr_b16 v[230:231], v224 offset:16896
    s_waitcnt lgkmcnt(12)
    v_mfma_f32_16x16x32_bf16 v[184:187], v[32:35], v[136:139], v[184:187]
    ds_read_b64_tr_b16 v[232:233], v225 offset:16384
    v_mfma_f32_16x16x32_bf16 v[188:191], v[32:35], v[140:143], v[188:191]
    ds_read_b64_tr_b16 v[234:235], v225 offset:16896
    v_mfma_f32_16x16x32_bf16 v[216:219], v[240:243], v[32:35], v[216:219]
    s_waitcnt lgkmcnt(12)
    v_mfma_f32_16x16x32_bf16 v[192:195], v[36:39], v[136:139], v[192:195]
    ds_read_b64_tr_b16 v[236:237], v4 offset:24576
    v_mfma_f32_16x16x32_bf16 v[196:199], v[36:39], v[140:143], v[196:199]
    ds_read_b64_tr_b16 v[238:239], v4 offset:25088
    v_mfma_f32_16x16x32_bf16 v[220:223], v[240:243], v[36:39], v[220:223]
    s_waitcnt lgkmcnt(12)
    v_mfma_f32_16x16x32_bf16 v[184:187], v[40:43], v[144:147], v[184:187]
    ds_read_b64_tr_b16 v[32:33], v5 offset:24576
    v_mfma_f32_16x16x32_bf16 v[188:191], v[40:43], v[148:151], v[188:191]
    ds_read_b64_tr_b16 v[34:35], v5 offset:25088
    s_waitcnt lgkmcnt(12)
    v_mfma_f32_16x16x32_bf16 v[192:195], v[44:47], v[144:147], v[192:195]
    ds_read_b64_tr_b16 v[36:37], v224 offset:24576
    v_mfma_f32_16x16x32_bf16 v[196:199], v[44:47], v[148:151], v[196:199]
    ds_read_b64_tr_b16 v[38:39], v224 offset:25088
    s_waitcnt lgkmcnt(12)
    v_mfma_f32_16x16x32_bf16 v[184:187], v[48:51], v[152:155], v[184:187]
    ds_read_b64_tr_b16 v[40:41], v225 offset:24576
    v_mfma_f32_16x16x32_bf16 v[188:191], v[48:51], v[156:159], v[188:191]
    ds_read_b64_tr_b16 v[42:43], v225 offset:25088
    v_mfma_f32_16x16x32_bf16 v[216:219], v[240:243], v[48:51], v[216:219]
    s_waitcnt lgkmcnt(12)
    v_mfma_f32_16x16x32_bf16 v[192:195], v[52:55], v[152:155], v[192:195]
    ds_read_b64_tr_b16 v[44:45], v6 offset:0
    v_mfma_f32_16x16x32_bf16 v[196:199], v[52:55], v[156:159], v[196:199]
    ds_read_b64_tr_b16 v[46:47], v6 offset:512
    v_mfma_f32_16x16x32_bf16 v[220:223], v[240:243], v[52:55], v[220:223]
    s_waitcnt lgkmcnt(12)
    v_mfma_f32_16x16x32_bf16 v[184:187], v[228:231], v[160:163], v[184:187]
    ds_read_b64_tr_b16 v[48:49], v7 offset:0
    v_mfma_f32_16x16x32_bf16 v[188:191], v[228:231], v[164:167], v[188:191]
    ds_read_b64_tr_b16 v[50:51], v7 offset:512
    s_waitcnt lgkmcnt(12)
    v_mfma_f32_16x16x32_bf16 v[192:195], v[232:235], v[160:163], v[192:195]
    ds_read_b64_tr_b16 v[52:53], v226 offset:0
    v_mfma_f32_16x16x32_bf16 v[196:199], v[232:235], v[164:167], v[196:199]
    ds_read_b64_tr_b16 v[54:55], v226 offset:512
    s_waitcnt lgkmcnt(12)
    v_mfma_f32_16x16x32_bf16 v[184:187], v[236:239], v[168:171], v[184:187]
    ds_read_b64_tr_b16 v[228:229], v227 offset:0
    v_mfma_f32_16x16x32_bf16 v[188:191], v[236:239], v[172:175], v[188:191]
    ds_read_b64_tr_b16 v[230:231], v227 offset:512
    v_mfma_f32_16x16x32_bf16 v[216:219], v[240:243], v[236:239], v[216:219]
    s_waitcnt lgkmcnt(12)
    v_mfma_f32_16x16x32_bf16 v[192:195], v[32:35], v[168:171], v[192:195]
    ds_read_b64_tr_b16 v[232:233], v6 offset:8192
    v_mfma_f32_16x16x32_bf16 v[196:199], v[32:35], v[172:175], v[196:199]
    ds_read_b64_tr_b16 v[234:235], v6 offset:8704
    v_mfma_f32_16x16x32_bf16 v[220:223], v[240:243], v[32:35], v[220:223]
    s_waitcnt lgkmcnt(12)
    v_mfma_f32_16x16x32_bf16 v[184:187], v[36:39], v[176:179], v[184:187]
    ds_read_b64_tr_b16 v[236:237], v7 offset:8192
    v_mfma_f32_16x16x32_bf16 v[188:191], v[36:39], v[180:183], v[188:191]
    ds_read_b64_tr_b16 v[238:239], v7 offset:8704
    s_waitcnt lgkmcnt(8)
    s_mov_b64 exec, 0xffff
    ds_add_f32 v10, v216 offset:256
    ds_add_f32 v10, v220 offset:320
    s_mov_b64 exec, -1
    v_mov_b32 v18, 155648
    v_mov_b32 v19, 1
    s_mov_b64 exec, 1
    ds_add_u32 v18, v19 offset:2112
    s_mov_b64 exec, -1
    v_mfma_f32_16x16x32_bf16 v[192:195], v[40:43], v[176:179], v[192:195]
    ds_read_b64_tr_b16 v[32:33], v226 offset:8192
    v_mfma_f32_16x16x32_bf16 v[196:199], v[40:43], v[180:183], v[196:199]
    ds_read_b64_tr_b16 v[34:35], v226 offset:8704
    v_mfma_f32_16x16x32_bf16 v[200:203], v[44:47], v[120:123], v[200:203]
    ds_read_b64_tr_b16 v[36:37], v227 offset:8192
    v_mfma_f32_16x16x32_bf16 v[204:207], v[44:47], v[124:127], v[204:207]
    ds_read_b64_tr_b16 v[38:39], v227 offset:8704
    s_waitcnt lgkmcnt(9)
    v_add_u32 v17, s63, v15
    ds_read_b32 v24, v17 offset:512
    ds_read_b32 v26, v17 offset:1024
    ds_read_b32 v28, v17 offset:576
    ds_read_b32 v30, v17 offset:1088
    s_waitcnt lgkmcnt(8)
K1_SPIN_F_1:
    ds_read_b32 v19, v18 offset:2112
    s_waitcnt lgkmcnt(0)
    v_readfirstlane_b32 s72, v19
    s_cmp_lt_u32 s72, 4
    s_cbranch_scc1 K1_SPIN_F_1
    v_xor_b32 v22, s79, v12
    ds_read_b128 v[240:243], v22 offset:256
    ds_read_b128 v[248:251], v22 offset:1792
    ds_read_b128 v[244:247], v22 offset:320
    ds_read_b128 v[252:255], v22 offset:1856
    v_mfma_f32_16x16x32_bf16 v[208:211], v[48:51], v[120:123], v[208:211]
    ds_read_b64_tr_b16 v[40:41], v6 offset:16384
    v_mfma_f32_16x16x32_bf16 v[212:215], v[48:51], v[124:127], v[212:215]
    ds_read_b64_tr_b16 v[42:43], v6 offset:16896
    v_mfma_f32_16x16x32_bf16 v[200:203], v[52:55], v[128:131], v[200:203]
    ds_read_b64_tr_b16 v[44:45], v7 offset:16384
    v_mfma_f32_16x16x32_bf16 v[204:207], v[52:55], v[132:135], v[204:207]
    ds_read_b64_tr_b16 v[46:47], v7 offset:16896
    v_mfma_f32_16x16x32_bf16 v[208:211], v[228:231], v[128:131], v[208:211]
    ds_read_b64_tr_b16 v[48:49], v226 offset:16384
    v_mfma_f32_16x16x32_bf16 v[212:215], v[228:231], v[132:135], v[212:215]
    ds_read_b64_tr_b16 v[50:51], v226 offset:16896
    s_waitcnt lgkmcnt(6)
    v_mul_f32 v24, v24, v26
    v_mul_f32 v28, v28, v30
    v_mfma_f32_16x16x32_bf16 v[200:203], v[232:235], v[136:139], v[200:203]
    ds_read_b64_tr_b16 v[52:53], v227 offset:16384
    v_mfma_f32_16x16x32_bf16 v[204:207], v[232:235], v[140:143], v[204:207]
    ds_read_b64_tr_b16 v[54:55], v227 offset:16896
    v_pk_fma_f32 v[72:73], v[24:25], v[240:241], v[248:249] op_sel_hi:[0,1,1] neg_lo:[1,0,0] neg_hi:[1,0,0]
    v_pk_fma_f32 v[74:75], v[24:25], v[242:243], v[250:251] op_sel_hi:[0,1,1] neg_lo:[1,0,0] neg_hi:[1,0,0]
    v_pk_fma_f32 v[76:77], v[24:25], v[244:245], v[252:253] op_sel_hi:[0,1,1] neg_lo:[1,0,0] neg_hi:[1,0,0]
    v_pk_fma_f32 v[78:79], v[24:25], v[246:247], v[254:255] op_sel_hi:[0,1,1] neg_lo:[1,0,0] neg_hi:[1,0,0]
    v_pk_fma_f32 v[72:73], v[26:27], v[184:185], v[72:73] op_sel_hi:[0,1,1]
    v_mfma_f32_16x16x32_bf16 v[208:211], v[236:239], v[136:139], v[208:211]
    ds_read_b64_tr_b16 v[228:229], v6 offset:24576
    v_mfma_f32_16x16x32_bf16 v[212:215], v[236:239], v[140:143], v[212:215]
    ds_read_b64_tr_b16 v[230:231], v6 offset:25088
    v_pk_fma_f32 v[74:75], v[26:27], v[186:187], v[74:75] op_sel_hi:[0,1,1]
    v_pk_fma_f32 v[76:77], v[26:27], v[192:193], v[76:77] op_sel_hi:[0,1,1]
    v_pk_fma_f32 v[78:79], v[26:27], v[194:195], v[78:79] op_sel_hi:[0,1,1]
    v_mul_f32 v72, v72, |v72|
    v_mul_f32 v73, v73, |v73|
    v_mfma_f32_16x16x32_bf16 v[200:203], v[32:35], v[144:147], v[200:203]
    ds_read_b64_tr_b16 v[232:233], v7 offset:24576
    v_mfma_f32_16x16x32_bf16 v[204:207], v[32:35], v[148:151], v[204:207]
    ds_read_b64_tr_b16 v[234:235], v7 offset:25088
    v_mul_f32 v74, v74, |v74|
    v_mul_f32 v75, v75, |v75|
    v_mul_f32 v76, v76, |v76|
    v_mul_f32 v77, v77, |v77|
    v_mul_f32 v78, v78, |v78|
    v_mfma_f32_16x16x32_bf16 v[208:211], v[36:39], v[144:147], v[208:211]
    ds_read_b64_tr_b16 v[236:237], v226 offset:24576
    v_mfma_f32_16x16x32_bf16 v[212:215], v[36:39], v[148:151], v[212:215]
    ds_read_b64_tr_b16 v[238:239], v226 offset:25088
    v_mul_f32 v79, v79, |v79|
    v_cvt_pk_bf16_f32 v80, v72, v73
    v_cvt_pk_bf16_f32 v81, v74, v75
    v_cvt_pk_bf16_f32 v82, v76, v77
    v_cvt_pk_bf16_f32 v83, v78, v79
    s_waitcnt lgkmcnt(12)
    v_mfma_f32_16x16x32_bf16 v[200:203], v[40:43], v[152:155], v[200:203]
    ds_read_b64_tr_b16 v[32:33], v227 offset:24576
    v_mfma_f32_16x16x32_bf16 v[204:207], v[40:43], v[156:159], v[204:207]
    ds_read_b64_tr_b16 v[34:35], v227 offset:25088
    v_pk_max_i16 v80, v80, 0
    v_pk_max_i16 v81, v81, 0
    v_pk_max_i16 v82, v82, 0
    v_pk_max_i16 v83, v83, 0
    buffer_store_dwordx4 v[80:83], v11, s[36:39], s60 offen sc1
    s_waitcnt lgkmcnt(12)
    v_mfma_f32_16x16x32_bf16 v[208:211], v[44:47], v[152:155], v[208:211]
    v_mfma_f32_16x16x32_bf16 v[212:215], v[44:47], v[156:159], v[212:215]
    v_pk_fma_f32 v[84:85], v[28:29], v[240:241], v[248:249] op_sel_hi:[0,1,1] neg_lo:[1,0,0] neg_hi:[1,0,0]
    v_pk_fma_f32 v[86:87], v[28:29], v[242:243], v[250:251] op_sel_hi:[0,1,1] neg_lo:[1,0,0] neg_hi:[1,0,0]
    v_pk_fma_f32 v[88:89], v[28:29], v[244:245], v[252:253] op_sel_hi:[0,1,1] neg_lo:[1,0,0] neg_hi:[1,0,0]
    v_pk_fma_f32 v[90:91], v[28:29], v[246:247], v[254:255] op_sel_hi:[0,1,1] neg_lo:[1,0,0] neg_hi:[1,0,0]
    v_pk_fma_f32 v[84:85], v[30:31], v[188:189], v[84:85] op_sel_hi:[0,1,1]
    s_waitcnt lgkmcnt(10)
    v_mfma_f32_16x16x32_bf16 v[200:203], v[48:51], v[160:163], v[200:203]
    v_mfma_f32_16x16x32_bf16 v[204:207], v[48:51], v[164:167], v[204:207]
    v_pk_fma_f32 v[86:87], v[30:31], v[190:191], v[86:87] op_sel_hi:[0,1,1]
    v_pk_fma_f32 v[88:89], v[30:31], v[196:197], v[88:89] op_sel_hi:[0,1,1]
    v_pk_fma_f32 v[90:91], v[30:31], v[198:199], v[90:91] op_sel_hi:[0,1,1]
    v_mul_f32 v84, v84, |v84|
    v_mul_f32 v85, v85, |v85|
    s_waitcnt lgkmcnt(8)
    v_mfma_f32_16x16x32_bf16 v[208:211], v[52:55], v[160:163], v[208:211]
    v_mfma_f32_16x16x32_bf16 v[212:215], v[52:55], v[164:167], v[212:215]
    v_mul_f32 v86, v86, |v86|
    v_mul_f32 v87, v87, |v87|
    v_mul_f32 v88, v88, |v88|
    v_mul_f32 v89, v89, |v89|
    v_mul_f32 v90, v90, |v90|
    v_xor_b32 v23, 0x80, v22
    ds_read_b128 v[56:59], v23 offset:256
    ds_read_b128 v[64:67], v23 offset:1792
    ds_read_b128 v[60:63], v23 offset:320
    ds_read_b128 v[68:71], v23 offset:1856
    s_waitcnt lgkmcnt(10)
    v_mfma_f32_16x16x32_bf16 v[200:203], v[228:231], v[168:171], v[200:203]
    v_mfma_f32_16x16x32_bf16 v[204:207], v[228:231], v[172:175], v[204:207]
    v_mul_f32 v91, v91, |v91|
    v_cvt_pk_bf16_f32 v92, v84, v85
    v_cvt_pk_bf16_f32 v93, v86, v87
    v_cvt_pk_bf16_f32 v94, v88, v89
    v_cvt_pk_bf16_f32 v95, v90, v91
    s_waitcnt lgkmcnt(8)
    v_mfma_f32_16x16x32_bf16 v[208:211], v[232:235], v[168:171], v[208:211]
    v_mfma_f32_16x16x32_bf16 v[212:215], v[232:235], v[172:175], v[212:215]
    v_pk_max_i16 v92, v92, 0
    v_pk_max_i16 v93, v93, 0
    v_pk_max_i16 v94, v94, 0
    v_pk_max_i16 v95, v95, 0
    buffer_store_dwordx4 v[92:95], v11, s[36:39], s61 offen sc1
    s_waitcnt lgkmcnt(6)
    v_mfma_f32_16x16x32_bf16 v[200:203], v[236:239], v[176:179], v[200:203]
    v_mfma_f32_16x16x32_bf16 v[204:207], v[236:239], v[180:183], v[204:207]
    s_waitcnt lgkmcnt(4)
    v_mfma_f32_16x16x32_bf16 v[208:211], v[32:35], v[176:179], v[208:211]
    v_mfma_f32_16x16x32_bf16 v[212:215], v[32:35], v[180:183], v[212:215]
    s_waitcnt lgkmcnt(0)
    s_nop 5
    s_add_u32 s60, s60, s65
    s_add_u32 s61, s61, s65
    v_pk_fma_f32 v[96:97], v[24:25], v[56:57], v[64:65] op_sel_hi:[0,1,1] neg_lo:[1,0,0] neg_hi:[1,0,0]
    v_pk_fma_f32 v[98:99], v[24:25], v[58:59], v[66:67] op_sel_hi:[0,1,1] neg_lo:[1,0,0] neg_hi:[1,0,0]
    v_pk_fma_f32 v[100:101], v[24:25], v[60:61], v[68:69] op_sel_hi:[0,1,1] neg_lo:[1,0,0] neg_hi:[1,0,0]
    v_pk_fma_f32 v[102:103], v[24:25], v[62:63], v[70:71] op_sel_hi:[0,1,1] neg_lo:[1,0,0] neg_hi:[1,0,0]
    v_pk_fma_f32 v[96:97], v[26:27], v[200:201], v[96:97] op_sel_hi:[0,1,1]
    v_pk_fma_f32 v[98:99], v[26:27], v[202:203], v[98:99] op_sel_hi:[0,1,1]
    v_pk_fma_f32 v[100:101], v[26:27], v[208:209], v[100:101] op_sel_hi:[0,1,1]
    v_pk_fma_f32 v[102:103], v[26:27], v[210:211], v[102:103] op_sel_hi:[0,1,1]
    v_mul_f32 v96, v96, |v96|
    v_mul_f32 v97, v97, |v97|
    v_mul_f32 v98, v98, |v98|
    v_mul_f32 v99, v99, |v99|
    v_mul_f32 v100, v100, |v100|
    v_mul_f32 v101, v101, |v101|
    v_mul_f32 v102, v102, |v102|
    v_mul_f32 v103, v103, |v103|
    v_cvt_pk_bf16_f32 v104, v96, v97
    v_cvt_pk_bf16_f32 v105, v98, v99
    v_cvt_pk_bf16_f32 v106, v100, v101
    v_cvt_pk_bf16_f32 v107, v102, v103
    v_pk_max_i16 v104, v104, 0
    v_pk_max_i16 v105, v105, 0
    v_pk_max_i16 v106, v106, 0
    v_pk_max_i16 v107, v107, 0
    buffer_store_dwordx4 v[104:107], v11, s[36:39], s60 offen sc1
    v_pk_fma_f32 v[108:109], v[28:29], v[56:57], v[64:65] op_sel_hi:[0,1,1] neg_lo:[1,0,0] neg_hi:[1,0,0]
    v_pk_fma_f32 v[110:111], v[28:29], v[58:59], v[66:67] op_sel_hi:[0,1,1] neg_lo:[1,0,0] neg_hi:[1,0,0]
    v_pk_fma_f32 v[112:113], v[28:29], v[60:61], v[68:69] op_sel_hi:[0,1,1] neg_lo:[1,0,0] neg_hi:[1,0,0]
    v_pk_fma_f32 v[114:115], v[28:29], v[62:63], v[70:71] op_sel_hi:[0,1,1] neg_lo:[1,0,0] neg_hi:[1,0,0]
    v_pk_fma_f32 v[108:109], v[30:31], v[204:205], v[108:109] op_sel_hi:[0,1,1]
    v_pk_fma_f32 v[110:111], v[30:31], v[206:207], v[110:111] op_sel_hi:[0,1,1]
    v_pk_fma_f32 v[112:113], v[30:31], v[212:213], v[112:113] op_sel_hi:[0,1,1]
    v_pk_fma_f32 v[114:115], v[30:31], v[214:215], v[114:115] op_sel_hi:[0,1,1]
    v_mul_f32 v108, v108, |v108|
    v_mul_f32 v109, v109, |v109|
    v_mul_f32 v110, v110, |v110|
    v_mul_f32 v111, v111, |v111|
    v_mul_f32 v112, v112, |v112|
    v_mul_f32 v113, v113, |v113|
    v_mul_f32 v114, v114, |v114|
    v_mul_f32 v115, v115, |v115|
    v_cvt_pk_bf16_f32 v116, v108, v109
    v_cvt_pk_bf16_f32 v117, v110, v111
    v_cvt_pk_bf16_f32 v118, v112, v113
    v_cvt_pk_bf16_f32 v119, v114, v115
    v_pk_max_i16 v116, v116, 0
    v_pk_max_i16 v117, v117, 0
    v_pk_max_i16 v118, v118, 0
    v_pk_max_i16 v119, v119, 0
    buffer_store_dwordx4 v[116:119], v11, s[36:39], s61 offen sc1
    s_endpgm
K1_VAR_D:
    s_barrier
    ds_read_b128 v[64:67], v8 offset:0
    ds_read_b128 v[68:71], v8 offset:2048
    ds_read_b64_tr_b16 v[32:33], v4 offset:0
    ds_read_b64_tr_b16 v[34:35], v4 offset:512
    ds_read_b64_tr_b16 v[36:37], v5 offset:0
    ds_read_b64_tr_b16 v[38:39], v5 offset:512
    ds_read_b64_tr_b16 v[40:41], v6 offset:0
    ds_read_b64_tr_b16 v[42:43], v6 offset:512
    ds_read_b64_tr_b16 v[44:45], v7 offset:0
    ds_read_b64_tr_b16 v[46:47], v7 offset:512
    ds_read_b128 v[72:75], v9 offset:0
    ds_read_b128 v[76:79], v9 offset:2048
    ds_read_b64_tr_b16 v[48:49], v160 offset:0
    ds_read_b64_tr_b16 v[50:51], v160 offset:512
    s_waitcnt lgkmcnt(10)
    v_mfma_f32_16x16x32_bf16 v[184:187], v[64:67], v[32:35], 0
    ds_read_b64_tr_b16 v[52:53], v161 offset:0
    v_mfma_f32_16x16x32_bf16 v[188:191], v[68:71], v[32:35], 0
    ds_read_b64_tr_b16 v[54:55], v161 offset:512
    v_mfma_f32_16x16x32_bf16 v[152:155], v[240:243], v[32:35], 0
    s_waitcnt lgkmcnt(10)
    v_mfma_f32_16x16x32_bf16 v[192:195], v[64:67], v[36:39], 0
    ds_read_b64_tr_b16 v[56:57], v162 offset:0
    v_mfma_f32_16x16x32_bf16 v[196:199], v[68:71], v[36:39], 0
    ds_read_b64_tr_b16 v[58:59], v162 offset:512
    v_mfma_f32_16x16x32_bf16 v[156:159], v[240:243], v[36:39], 0
    s_waitcnt lgkmcnt(10)
    v_mfma_f32_16x16x32_bf16 v[200:203], v[64:67], v[40:43], 0
    ds_read_b64_tr_b16 v[60:61], v163 offset:0
    v_mfma_f32_16x16x32_bf16 v[204:207], v[68:71], v[40:43], 0
    ds_read_b64_tr_b16 v[62:63], v163 offset:512
    s_barrier
    s_waitcnt lgkmcnt(10)
    v_mfma_f32_16x16x32_bf16 v[208:211], v[64:67], v[44:47], 0
    ds_read_b128 v[80:83], v8 offset:24576
    ds_read_b128 v[84:87], v8 offset:26624
    v_mfma_f32_16x16x32_bf16 v[212:215], v[68:71], v[44:47], 0
    ds_read_b64_tr_b16 v[32:33], v4 offset:24576
    v_mfma_f32_16x16x32_bf16 v[216:219], v[64:67], v[88:91], 0
    ds_read_b64_tr_b16 v[34:35], v4 offset:25088
    v_mfma_f32_16x16x32_bf16 v[220:223], v[68:71], v[88:91], 0
    s_waitcnt lgkmcnt(10)
    v_mfma_f32_16x16x32_bf16 v[184:187], v[72:75], v[48:51], v[184:187]
    ds_read_b64_tr_b16 v[36:37], v5 offset:24576
    v_mfma_f32_16x16x32_bf16 v[188:191], v[76:79], v[48:51], v[188:191]
    ds_read_b64_tr_b16 v[38:39], v5 offset:25088
    s_waitcnt lgkmcnt(10)
    v_mfma_f32_16x16x32_bf16 v[192:195], v[72:75], v[52:55], v[192:195]
    ds_read_b64_tr_b16 v[40:41], v6 offset:24576
    v_mfma_f32_16x16x32_bf16 v[196:199], v[76:79], v[52:55], v[196:199]
    ds_read_b64_tr_b16 v[42:43], v6 offset:25088
    s_waitcnt lgkmcnt(10)
    v_mfma_f32_16x16x32_bf16 v[200:203], v[72:75], v[56:59], v[200:203]
    ds_read_b64_tr_b16 v[44:45], v7 offset:24576
    v_mfma_f32_16x16x32_bf16 v[204:207], v[76:79], v[56:59], v[204:207]
    ds_read_b64_tr_b16 v[46:47], v7 offset:25088
    s_waitcnt lgkmcnt(10)
    v_mfma_f32_16x16x32_bf16 v[208:211], v[72:75], v[60:63], v[208:211]
    ds_read_b128 v[64:67], v9 offset:24576
    ds_read_b128 v[68:71], v9 offset:26624
    v_mfma_f32_16x16x32_bf16 v[212:215], v[76:79], v[60:63], v[212:215]
    ds_read_b64_tr_b16 v[48:49], v160 offset:24576
    v_mfma_f32_16x16x32_bf16 v[216:219], v[72:75], v[92:95], v[216:219]
    ds_read_b64_tr_b16 v[50:51], v160 offset:25088
    v_mfma_f32_16x16x32_bf16 v[220:223], v[76:79], v[92:95], v[220:223]
    s_waitcnt lgkmcnt(10)
    v_mfma_f32_16x16x32_bf16 v[184:187], v[80:83], v[32:35], v[184:187]
    ds_read_b64_tr_b16 v[52:53], v161 offset:24576
    v_mfma_f32_16x16x32_bf16 v[188:191], v[84:87], v[32:35], v[188:191]
    ds_read_b64_tr_b16 v[54:55], v161 offset:25088
    v_mfma_f32_16x16x32_bf16 v[152:155], v[240:243], v[32:35], v[152:155]
    s_waitcnt lgkmcnt(10)
    v_mfma_f32_16x16x32_bf16 v[192:195], v[80:83], v[36:39], v[192:195]
    ds_read_b64_tr_b16 v[56:57], v162 offset:24576
    v_mfma_f32_16x16x32_bf16 v[196:199], v[84:87], v[36:39], v[196:199]
    ds_read_b64_tr_b16 v[58:59], v162 offset:25088
    v_mfma_f32_16x16x32_bf16 v[156:159], v[240:243], v[36:39], v[156:159]
    s_waitcnt lgkmcnt(10)
    v_mfma_f32_16x16x32_bf16 v[200:203], v[80:83], v[40:43], v[200:203]
    ds_read_b64_tr_b16 v[60:61], v163 offset:24576
    v_mfma_f32_16x16x32_bf16 v[204:207], v[84:87], v[40:43], v[204:207]
    ds_read_b64_tr_b16 v[62:63], v163 offset:25088
    s_barrier
    s_waitcnt lgkmcnt(10)
    v_mfma_f32_16x16x32_bf16 v[208:211], v[80:83], v[44:47], v[208:211]
    ds_read_b128 v[72:75], v8 offset:49152
    ds_read_b128 v[76:79], v8 offset:51200
    v_mfma_f32_16x16x32_bf16 v[212:215], v[84:87], v[44:47], v[212:215]
    ds_read_b64_tr_b16 v[32:33], v4 offset:49152
    v_mfma_f32_16x16x32_bf16 v[216:219], v[80:83], v[96:99], v[216:219]
    ds_read_b64_tr_b16 v[34:35], v4 offset:49664
    v_mfma_f32_16x16x32_bf16 v[220:223], v[84:87], v[96:99], v[220:223]
    s_waitcnt lgkmcnt(10)
    v_mfma_f32_16x16x32_bf16 v[184:187], v[64:67], v[48:51], v[184:187]
    ds_read_b64_tr_b16 v[36:37], v5 offset:49152
    v_mfma_f32_16x16x32_bf16 v[188:191], v[68:71], v[48:51], v[188:191]
    ds_read_b64_tr_b16 v[38:39], v5 offset:49664
    s_waitcnt lgkmcnt(10)
    v_mfma_f32_16x16x32_bf16 v[192:195], v[64:67], v[52:55], v[192:195]
    ds_read_b64_tr_b16 v[40:41], v6 offset:49152
    v_mfma_f32_16x16x32_bf16 v[196:199], v[68:71], v[52:55], v[196:199]
    ds_read_b64_tr_b16 v[42:43], v6 offset:49664
    s_waitcnt lgkmcnt(10)
    v_mfma_f32_16x16x32_bf16 v[200:203], v[64:67], v[56:59], v[200:203]
    ds_read_b64_tr_b16 v[44:45], v7 offset:49152
    v_mfma_f32_16x16x32_bf16 v[204:207], v[68:71], v[56:59], v[204:207]
    ds_read_b64_tr_b16 v[46:47], v7 offset:49664
    s_waitcnt lgkmcnt(10)
    v_mfma_f32_16x16x32_bf16 v[208:211], v[64:67], v[60:63], v[208:211]
    ds_read_b128 v[80:83], v9 offset:49152
    ds_read_b128 v[84:87], v9 offset:51200
    v_mfma_f32_16x16x32_bf16 v[212:215], v[68:71], v[60:63], v[212:215]
    ds_read_b64_tr_b16 v[48:49], v160 offset:49152
    v_mfma_f32_16x16x32_bf16 v[216:219], v[64:67], v[100:103], v[216:219]
    ds_read_b64_tr_b16 v[50:51], v160 offset:49664
    v_mfma_f32_16x16x32_bf16 v[220:223], v[68:71], v[100:103], v[220:223]
    s_waitcnt lgkmcnt(10)
    v_mfma_f32_16x16x32_bf16 v[184:187], v[72:75], v[32:35], v[184:187]
    ds_read_b64_tr_b16 v[52:53], v161 offset:49152
    v_mfma_f32_16x16x32_bf16 v[188:191], v[76:79], v[32:35], v[188:191]
    ds_read_b64_tr_b16 v[54:55], v161 offset:49664
    v_mfma_f32_16x16x32_bf16 v[152:155], v[240:243], v[32:35], v[152:155]
    s_waitcnt lgkmcnt(10)
    v_mfma_f32_16x16x32_bf16 v[192:195], v[72:75], v[36:39], v[192:195]
    ds_read_b64_tr_b16 v[56:57], v162 offset:49152
    v_mfma_f32_16x16x32_bf16 v[196:199], v[76:79], v[36:39], v[196:199]
    ds_read_b64_tr_b16 v[58:59], v162 offset:49664
    v_mfma_f32_16x16x32_bf16 v[156:159], v[240:243], v[36:39], v[156:159]
    s_waitcnt lgkmcnt(10)
    v_mfma_f32_16x16x32_bf16 v[200:203], v[72:75], v[40:43], v[200:203]
    ds_read_b64_tr_b16 v[60:61], v163 offset:49152
    v_mfma_f32_16x16x32_bf16 v[204:207], v[76:79], v[40:43], v[204:207]
    ds_read_b64_tr_b16 v[62:63], v163 offset:49664
    v_add_u32 v4, 73728, v4
    v_add_u32 v5, 73728, v5
    v_add_u32 v6, 73728, v6
    v_add_u32 v7, 73728, v7
    v_add_u32 v8, 73728, v8
    v_add_u32 v9, 73728, v9
    v_add_u32 v160, 73728, v160
    v_add_u32 v161, 73728, v161
    v_add_u32 v162, 73728, v162
    v_add_u32 v163, 73728, v163
    s_barrier
    s_waitcnt lgkmcnt(10)
    v_mfma_f32_16x16x32_bf16 v[208:211], v[72:75], v[44:47], v[208:211]
    ds_read_b128 v[64:67], v8 offset:0
    ds_read_b128 v[68:71], v8 offset:2048
    v_mfma_f32_16x16x32_bf16 v[212:215], v[76:79], v[44:47], v[212:215]
    ds_read_b64_tr_b16 v[32:33], v4 offset:0
    v_mfma_f32_16x16x32_bf16 v[216:219], v[72:75], v[104:107], v[216:219]
    ds_read_b64_tr_b16 v[34:35], v4 offset:512
    v_mfma_f32_16x16x32_bf16 v[220:223], v[76:79], v[104:107], v[220:223]
    s_waitcnt lgkmcnt(10)
    v_mfma_f32_16x16x32_bf16 v[184:187], v[80:83], v[48:51], v[184:187]
    ds_read_b64_tr_b16 v[36:37], v5 offset:0
    v_mfma_f32_16x16x32_bf16 v[188:191], v[84:87], v[48:51], v[188:191]
    ds_read_b64_tr_b16 v[38:39], v5 offset:512
    s_waitcnt lgkmcnt(10)
    v_mfma_f32_16x16x32_bf16 v[192:195], v[80:83], v[52:55], v[192:195]
    ds_read_b64_tr_b16 v[40:41], v6 offset:0
    v_mfma_f32_16x16x32_bf16 v[196:199], v[84:87], v[52:55], v[196:199]
    ds_read_b64_tr_b16 v[42:43], v6 offset:512
    s_waitcnt lgkmcnt(10)
    v_mfma_f32_16x16x32_bf16 v[200:203], v[80:83], v[56:59], v[200:203]
    ds_read_b64_tr_b16 v[44:45], v7 offset:0
    v_mfma_f32_16x16x32_bf16 v[204:207], v[84:87], v[56:59], v[204:207]
    ds_read_b64_tr_b16 v[46:47], v7 offset:512
    s_waitcnt lgkmcnt(10)
    v_mfma_f32_16x16x32_bf16 v[208:211], v[80:83], v[60:63], v[208:211]
    ds_read_b128 v[72:75], v9 offset:0
    ds_read_b128 v[76:79], v9 offset:2048
    v_mfma_f32_16x16x32_bf16 v[212:215], v[84:87], v[60:63], v[212:215]
    ds_read_b64_tr_b16 v[48:49], v160 offset:0
    v_mfma_f32_16x16x32_bf16 v[216:219], v[80:83], v[108:111], v[216:219]
    ds_read_b64_tr_b16 v[50:51], v160 offset:512
    v_mfma_f32_16x16x32_bf16 v[220:223], v[84:87], v[108:111], v[220:223]
    s_waitcnt lgkmcnt(10)
    v_mfma_f32_16x16x32_bf16 v[184:187], v[64:67], v[32:35], v[184:187]
    ds_read_b64_tr_b16 v[52:53], v161 offset:0
    v_mfma_f32_16x16x32_bf16 v[188:191], v[68:71], v[32:35], v[188:191]
    ds_read_b64_tr_b16 v[54:55], v161 offset:512
    v_mfma_f32_16x16x32_bf16 v[152:155], v[240:243], v[32:35], v[152:155]
    s_waitcnt lgkmcnt(10)
    v_mfma_f32_16x16x32_bf16 v[192:195], v[64:67], v[36:39], v[192:195]
    ds_read_b64_tr_b16 v[56:57], v162 offset:0
    v_mfma_f32_16x16x32_bf16 v[196:199], v[68:71], v[36:39], v[196:199]
    ds_read_b64_tr_b16 v[58:59], v162 offset:512
    v_mfma_f32_16x16x32_bf16 v[156:159], v[240:243], v[36:39], v[156:159]
    s_waitcnt lgkmcnt(10)
    v_mfma_f32_16x16x32_bf16 v[200:203], v[64:67], v[40:43], v[200:203]
    ds_read_b64_tr_b16 v[60:61], v163 offset:0
    v_mfma_f32_16x16x32_bf16 v[204:207], v[68:71], v[40:43], v[204:207]
    ds_read_b64_tr_b16 v[62:63], v163 offset:512
    s_barrier
    s_waitcnt lgkmcnt(10)
    v_mfma_f32_16x16x32_bf16 v[208:211], v[64:67], v[44:47], v[208:211]
    ds_read_b128 v[80:83], v8 offset:24576
    ds_read_b128 v[84:87], v8 offset:26624
    v_mfma_f32_16x16x32_bf16 v[212:215], v[68:71], v[44:47], v[212:215]
    ds_read_b64_tr_b16 v[32:33], v4 offset:24576
    v_mfma_f32_16x16x32_bf16 v[216:219], v[64:67], v[112:115], v[216:219]
    ds_read_b64_tr_b16 v[34:35], v4 offset:25088
    v_mfma_f32_16x16x32_bf16 v[220:223], v[68:71], v[112:115], v[220:223]
    s_waitcnt lgkmcnt(10)
    v_mfma_f32_16x16x32_bf16 v[184:187], v[72:75], v[48:51], v[184:187]
    ds_read_b64_tr_b16 v[36:37], v5 offset:24576
    v_mfma_f32_16x16x32_bf16 v[188:191], v[76:79], v[48:51], v[188:191]
    ds_read_b64_tr_b16 v[38:39], v5 offset:25088
    s_waitcnt lgkmcnt(10)
    v_mfma_f32_16x16x32_bf16 v[192:195], v[72:75], v[52:55], v[192:195]
    ds_read_b64_tr_b16 v[40:41], v6 offset:24576
    v_mfma_f32_16x16x32_bf16 v[196:199], v[76:79], v[52:55], v[196:199]
    ds_read_b64_tr_b16 v[42:43], v6 offset:25088
    s_waitcnt lgkmcnt(10)
    v_mfma_f32_16x16x32_bf16 v[200:203], v[72:75], v[56:59], v[200:203]
    ds_read_b64_tr_b16 v[44:45], v7 offset:24576
    v_mfma_f32_16x16x32_bf16 v[204:207], v[76:79], v[56:59], v[204:207]
    ds_read_b64_tr_b16 v[46:47], v7 offset:25088
    s_waitcnt lgkmcnt(10)
    v_mfma_f32_16x16x32_bf16 v[208:211], v[72:75], v[60:63], v[208:211]
    ds_read_b128 v[64:67], v9 offset:24576
    ds_read_b128 v[68:71], v9 offset:26624
    v_mfma_f32_16x16x32_bf16 v[212:215], v[76:79], v[60:63], v[212:215]
    ds_read_b64_tr_b16 v[48:49], v160 offset:24576
    v_mfma_f32_16x16x32_bf16 v[216:219], v[72:75], v[116:119], v[216:219]
    ds_read_b64_tr_b16 v[50:51], v160 offset:25088
    v_mfma_f32_16x16x32_bf16 v[220:223], v[76:79], v[116:119], v[220:223]
    s_waitcnt lgkmcnt(10)
    v_mfma_f32_16x16x32_bf16 v[184:187], v[80:83], v[32:35], v[184:187]
    ds_read_b64_tr_b16 v[52:53], v161 offset:24576
    v_mfma_f32_16x16x32_bf16 v[188:191], v[84:87], v[32:35], v[188:191]
    ds_read_b64_tr_b16 v[54:55], v161 offset:25088
    v_mfma_f32_16x16x32_bf16 v[152:155], v[240:243], v[32:35], v[152:155]
    s_waitcnt lgkmcnt(10)
    v_mfma_f32_16x16x32_bf16 v[192:195], v[80:83], v[36:39], v[192:195]
    ds_read_b64_tr_b16 v[56:57], v162 offset:24576
    v_mfma_f32_16x16x32_bf16 v[196:199], v[84:87], v[36:39], v[196:199]
    ds_read_b64_tr_b16 v[58:59], v162 offset:25088
    v_mfma_f32_16x16x32_bf16 v[156:159], v[240:243], v[36:39], v[156:159]
    s_waitcnt lgkmcnt(10)
    v_mfma_f32_16x16x32_bf16 v[200:203], v[80:83], v[40:43], v[200:203]
    ds_read_b64_tr_b16 v[60:61], v163 offset:24576
    v_mfma_f32_16x16x32_bf16 v[204:207], v[84:87], v[40:43], v[204:207]
    ds_read_b64_tr_b16 v[62:63], v163 offset:25088
    v_subrev_u32 v4, 73728, v4
    v_subrev_u32 v5, 73728, v5
    v_subrev_u32 v6, 73728, v6
    v_subrev_u32 v7, 73728, v7
    v_subrev_u32 v8, 73728, v8
    v_subrev_u32 v9, 73728, v9
    v_subrev_u32 v160, 73728, v160
    v_subrev_u32 v161, 73728, v161
    v_subrev_u32 v162, 73728, v162
    v_subrev_u32 v163, 73728, v163
    s_barrier
    s_waitcnt lgkmcnt(10)
    v_mfma_f32_16x16x32_bf16 v[208:211], v[80:83], v[44:47], v[208:211]
    ds_read_b128 v[72:75], v8 offset:0
    ds_read_b128 v[76:79], v8 offset:2048
    v_mfma_f32_16x16x32_bf16 v[212:215], v[84:87], v[44:47], v[212:215]
    ds_read_b64_tr_b16 v[32:33], v4 offset:0
    v_mfma_f32_16x16x32_bf16 v[216:219], v[80:83], v[120:123], v[216:219]
    ds_read_b64_tr_b16 v[34:35], v4 offset:512
    v_mfma_f32_16x16x32_bf16 v[220:223], v[84:87], v[120:123], v[220:223]
    s_waitcnt lgkmcnt(10)
    v_mfma_f32_16x16x32_bf16 v[184:187], v[64:67], v[48:51], v[184:187]
    ds_read_b64_tr_b16 v[36:37], v5 offset:0
    v_mfma_f32_16x16x32_bf16 v[188:191], v[68:71], v[48:51], v[188:191]
    ds_read_b64_tr_b16 v[38:39], v5 offset:512
    s_waitcnt lgkmcnt(10)
    v_mfma_f32_16x16x32_bf16 v[192:195], v[64:67], v[52:55], v[192:195]
    ds_read_b64_tr_b16 v[40:41], v6 offset:0
    v_mfma_f32_16x16x32_bf16 v[196:199], v[68:71], v[52:55], v[196:199]
    ds_read_b64_tr_b16 v[42:43], v6 offset:512
    s_waitcnt lgkmcnt(10)
    v_mfma_f32_16x16x32_bf16 v[200:203], v[64:67], v[56:59], v[200:203]
    ds_read_b64_tr_b16 v[44:45], v7 offset:0
    v_mfma_f32_16x16x32_bf16 v[204:207], v[68:71], v[56:59], v[204:207]
    ds_read_b64_tr_b16 v[46:47], v7 offset:512
    s_waitcnt lgkmcnt(10)
    v_mfma_f32_16x16x32_bf16 v[208:211], v[64:67], v[60:63], v[208:211]
    ds_read_b128 v[80:83], v9 offset:0
    ds_read_b128 v[84:87], v9 offset:2048
    v_mfma_f32_16x16x32_bf16 v[212:215], v[68:71], v[60:63], v[212:215]
    ds_read_b64_tr_b16 v[48:49], v160 offset:0
    v_mfma_f32_16x16x32_bf16 v[216:219], v[64:67], v[124:127], v[216:219]
    ds_read_b64_tr_b16 v[50:51], v160 offset:512
    v_mfma_f32_16x16x32_bf16 v[220:223], v[68:71], v[124:127], v[220:223]
    s_waitcnt lgkmcnt(10)
    v_mfma_f32_16x16x32_bf16 v[184:187], v[72:75], v[32:35], v[184:187]
    ds_read_b64_tr_b16 v[52:53], v161 offset:0
    v_mfma_f32_16x16x32_bf16 v[188:191], v[76:79], v[32:35], v[188:191]
    ds_read_b64_tr_b16 v[54:55], v161 offset:512
    v_mfma_f32_16x16x32_bf16 v[152:155], v[240:243], v[32:35], v[152:155]
    s_waitcnt lgkmcnt(10)
    v_mfma_f32_16x16x32_bf16 v[192:195], v[72:75], v[36:39], v[192:195]
    ds_read_b64_tr_b16 v[56:57], v162 offset:0
    v_mfma_f32_16x16x32_bf16 v[196:199], v[76:79], v[36:39], v[196:199]
    ds_read_b64_tr_b16 v[58:59], v162 offset:512
    v_mfma_f32_16x16x32_bf16 v[156:159], v[240:243], v[36:39], v[156:159]
    s_waitcnt lgkmcnt(10)
    v_mfma_f32_16x16x32_bf16 v[200:203], v[72:75], v[40:43], v[200:203]
    ds_read_b64_tr_b16 v[60:61], v163 offset:0
    v_mfma_f32_16x16x32_bf16 v[204:207], v[76:79], v[40:43], v[204:207]
    ds_read_b64_tr_b16 v[62:63], v163 offset:512
    s_barrier
    s_waitcnt lgkmcnt(10)
    v_mfma_f32_16x16x32_bf16 v[208:211], v[72:75], v[44:47], v[208:211]
    ds_read_b128 v[64:67], v8 offset:24576
    ds_read_b128 v[68:71], v8 offset:26624
    v_mfma_f32_16x16x32_bf16 v[212:215], v[76:79], v[44:47], v[212:215]
    ds_read_b64_tr_b16 v[32:33], v4 offset:24576
    v_mfma_f32_16x16x32_bf16 v[216:219], v[72:75], v[128:131], v[216:219]
    ds_read_b64_tr_b16 v[34:35], v4 offset:25088
    v_mfma_f32_16x16x32_bf16 v[220:223], v[76:79], v[128:131], v[220:223]
    s_waitcnt lgkmcnt(10)
    v_mfma_f32_16x16x32_bf16 v[184:187], v[80:83], v[48:51], v[184:187]
    ds_read_b64_tr_b16 v[36:37], v5 offset:24576
    v_mfma_f32_16x16x32_bf16 v[188:191], v[84:87], v[48:51], v[188:191]
    ds_read_b64_tr_b16 v[38:39], v5 offset:25088
    s_waitcnt lgkmcnt(10)
    v_mfma_f32_16x16x32_bf16 v[192:195], v[80:83], v[52:55], v[192:195]
    ds_read_b64_tr_b16 v[40:41], v6 offset:24576
    v_mfma_f32_16x16x32_bf16 v[196:199], v[84:87], v[52:55], v[196:199]
    ds_read_b64_tr_b16 v[42:43], v6 offset:25088
    s_waitcnt lgkmcnt(10)
    v_mfma_f32_16x16x32_bf16 v[200:203], v[80:83], v[56:59], v[200:203]
    ds_read_b64_tr_b16 v[44:45], v7 offset:24576
    v_mfma_f32_16x16x32_bf16 v[204:207], v[84:87], v[56:59], v[204:207]
    ds_read_b64_tr_b16 v[46:47], v7 offset:25088
    s_waitcnt lgkmcnt(10)
    v_mfma_f32_16x16x32_bf16 v[208:211], v[80:83], v[60:63], v[208:211]
    ds_read_b128 v[72:75], v9 offset:24576
    ds_read_b128 v[76:79], v9 offset:26624
    v_mfma_f32_16x16x32_bf16 v[212:215], v[84:87], v[60:63], v[212:215]
    ds_read_b64_tr_b16 v[48:49], v160 offset:24576
    v_mfma_f32_16x16x32_bf16 v[216:219], v[80:83], v[132:135], v[216:219]
    ds_read_b64_tr_b16 v[50:51], v160 offset:25088
    v_mfma_f32_16x16x32_bf16 v[220:223], v[84:87], v[132:135], v[220:223]
    s_waitcnt lgkmcnt(10)
    v_mfma_f32_16x16x32_bf16 v[184:187], v[64:67], v[32:35], v[184:187]
    ds_read_b64_tr_b16 v[52:53], v161 offset:24576
    v_mfma_f32_16x16x32_bf16 v[188:191], v[68:71], v[32:35], v[188:191]
    ds_read_b64_tr_b16 v[54:55], v161 offset:25088
    v_mfma_f32_16x16x32_bf16 v[152:155], v[240:243], v[32:35], v[152:155]
    s_waitcnt lgkmcnt(10)
    v_mfma_f32_16x16x32_bf16 v[192:195], v[64:67], v[36:39], v[192:195]
    ds_read_b64_tr_b16 v[56:57], v162 offset:24576
    v_mfma_f32_16x16x32_bf16 v[196:199], v[68:71], v[36:39], v[196:199]
    ds_read_b64_tr_b16 v[58:59], v162 offset:25088
    v_mfma_f32_16x16x32_bf16 v[156:159], v[240:243], v[36:39], v[156:159]
    s_waitcnt lgkmcnt(10)
    v_mfma_f32_16x16x32_bf16 v[200:203], v[64:67], v[40:43], v[200:203]
    ds_read_b64_tr_b16 v[60:61], v163 offset:24576
    v_mfma_f32_16x16x32_bf16 v[204:207], v[68:71], v[40:43], v[204:207]
    ds_read_b64_tr_b16 v[62:63], v163 offset:25088
    s_barrier
    s_waitcnt lgkmcnt(10)
    v_mfma_f32_16x16x32_bf16 v[208:211], v[64:67], v[44:47], v[208:211]
    ds_read_b128 v[80:83], v8 offset:49152
    ds_read_b128 v[84:87], v8 offset:51200
    v_mfma_f32_16x16x32_bf16 v[212:215], v[68:71], v[44:47], v[212:215]
    ds_read_b64_tr_b16 v[32:33], v4 offset:49152
    v_mfma_f32_16x16x32_bf16 v[216:219], v[64:67], v[136:139], v[216:219]
    ds_read_b64_tr_b16 v[34:35], v4 offset:49664
    v_mfma_f32_16x16x32_bf16 v[220:223], v[68:71], v[136:139], v[220:223]
    s_waitcnt lgkmcnt(10)
    v_mfma_f32_16x16x32_bf16 v[184:187], v[72:75], v[48:51], v[184:187]
    ds_read_b64_tr_b16 v[36:37], v5 offset:49152
    v_mfma_f32_16x16x32_bf16 v[188:191], v[76:79], v[48:51], v[188:191]
    ds_read_b64_tr_b16 v[38:39], v5 offset:49664
    s_waitcnt lgkmcnt(10)
    v_mfma_f32_16x16x32_bf16 v[192:195], v[72:75], v[52:55], v[192:195]
    ds_read_b64_tr_b16 v[40:41], v6 offset:49152
    v_mfma_f32_16x16x32_bf16 v[196:199], v[76:79], v[52:55], v[196:199]
    ds_read_b64_tr_b16 v[42:43], v6 offset:49664
    s_waitcnt lgkmcnt(10)
    v_mfma_f32_16x16x32_bf16 v[200:203], v[72:75], v[56:59], v[200:203]
    ds_read_b64_tr_b16 v[44:45], v7 offset:49152
    v_mfma_f32_16x16x32_bf16 v[204:207], v[76:79], v[56:59], v[204:207]
    ds_read_b64_tr_b16 v[46:47], v7 offset:49664
    s_waitcnt lgkmcnt(10)
    v_mfma_f32_16x16x32_bf16 v[208:211], v[72:75], v[60:63], v[208:211]
    ds_read_b128 v[64:67], v9 offset:49152
    ds_read_b128 v[68:71], v9 offset:51200
    v_mfma_f32_16x16x32_bf16 v[212:215], v[76:79], v[60:63], v[212:215]
    ds_read_b64_tr_b16 v[48:49], v160 offset:49152
    v_mfma_f32_16x16x32_bf16 v[216:219], v[72:75], v[140:143], v[216:219]
    ds_read_b64_tr_b16 v[50:51], v160 offset:49664
    v_mfma_f32_16x16x32_bf16 v[220:223], v[76:79], v[140:143], v[220:223]
    s_waitcnt lgkmcnt(10)
    v_mfma_f32_16x16x32_bf16 v[184:187], v[80:83], v[32:35], v[184:187]
    ds_read_b64_tr_b16 v[52:53], v161 offset:49152
    v_mfma_f32_16x16x32_bf16 v[188:191], v[84:87], v[32:35], v[188:191]
    ds_read_b64_tr_b16 v[54:55], v161 offset:49664
    v_mfma_f32_16x16x32_bf16 v[152:155], v[240:243], v[32:35], v[152:155]
    s_waitcnt lgkmcnt(10)
    v_mfma_f32_16x16x32_bf16 v[192:195], v[80:83], v[36:39], v[192:195]
    ds_read_b64_tr_b16 v[56:57], v162 offset:49152
    v_mfma_f32_16x16x32_bf16 v[196:199], v[84:87], v[36:39], v[196:199]
    ds_read_b64_tr_b16 v[58:59], v162 offset:49664
    v_mfma_f32_16x16x32_bf16 v[156:159], v[240:243], v[36:39], v[156:159]
    s_waitcnt lgkmcnt(10)
    v_mfma_f32_16x16x32_bf16 v[200:203], v[80:83], v[40:43], v[200:203]
    ds_read_b64_tr_b16 v[60:61], v163 offset:49152
    v_mfma_f32_16x16x32_bf16 v[204:207], v[84:87], v[40:43], v[204:207]
    ds_read_b64_tr_b16 v[62:63], v163 offset:49664
    s_waitcnt lgkmcnt(10)
    v_mfma_f32_16x16x32_bf16 v[208:211], v[80:83], v[44:47], v[208:211]
    v_mfma_f32_16x16x32_bf16 v[212:215], v[84:87], v[44:47], v[212:215]
    v_mfma_f32_16x16x32_bf16 v[216:219], v[80:83], v[144:147], v[216:219]
    v_mfma_f32_16x16x32_bf16 v[220:223], v[84:87], v[144:147], v[220:223]
    s_waitcnt lgkmcnt(6)
    v_mfma_f32_16x16x32_bf16 v[184:187], v[64:67], v[48:51], v[184:187]
    v_mfma_f32_16x16x32_bf16 v[188:191], v[68:71], v[48:51], v[188:191]
    s_waitcnt lgkmcnt(4)
    v_mfma_f32_16x16x32_bf16 v[192:195], v[64:67], v[52:55], v[192:195]
    v_mfma_f32_16x16x32_bf16 v[196:199], v[68:71], v[52:55], v[196:199]
    s_waitcnt lgkmcnt(2)
    v_mfma_f32_16x16x32_bf16 v[200:203], v[64:67], v[56:59], v[200:203]
    v_mfma_f32_16x16x32_bf16 v[204:207], v[68:71], v[56:59], v[204:207]
    s_waitcnt lgkmcnt(0)
    v_mfma_f32_16x16x32_bf16 v[208:211], v[64:67], v[60:63], v[208:211]
    v_mfma_f32_16x16x32_bf16 v[212:215], v[68:71], v[60:63], v[212:215]
    v_mfma_f32_16x16x32_bf16 v[216:219], v[64:67], v[148:151], v[216:219]
    v_mfma_f32_16x16x32_bf16 v[220:223], v[68:71], v[148:151], v[220:223]
    v_add_u32 v17, s63, v15
    s_mov_b64 exec, 0xffff
    ds_add_f32 v10, v152 offset:0
    ds_add_f32 v10, v156 offset:64
    s_mov_b64 exec, -1
    s_waitcnt lgkmcnt(0)
    s_barrier
    v_add_u32 v20, s63, v12
    ds_read_b128 v[240:243], v20 offset:512
    ds_read_b128 v[244:247], v20 offset:1024
    ds_read_b128 v[248:251], v20 offset:576
    ds_read_b128 v[252:255], v20 offset:1088
    v_xor_b32 v23, 0x80, v10
    ds_read_b32 v24, v10 offset:0
    ds_read_b32 v25, v10 offset:64
    ds_read_b32 v26, v23 offset:0
    ds_read_b32 v27, v23 offset:64
    s_waitcnt lgkmcnt(0)
    v_fma_f32 v36, -v240, v24, v184
    v_fma_f32 v37, -v241, v24, v185
    v_fma_f32 v38, -v242, v24, v186
    v_fma_f32 v39, -v243, v24, v187
    v_mul_f32 v36, v36, v244
    v_mul_f32 v37, v37, v245
    v_mul_f32 v38, v38, v246
    v_mul_f32 v39, v39, v247
    v_add_f32 v40, v36, v37
    v_add_f32 v41, v38, v39
    v_add_f32 v32, v40, v41
    v_sub_f32 v34, v40, v41
    v_sub_f32 v42, v36, v37
    v_cndmask_b32 v32, v32, v40, s[76:77]
    v_cndmask_b32 v34, v34, v42, s[76:77]
    s_cmp_eq_u32 s76, 0
    s_cbranch_scc1 K1_NOX_D_0
    s_mov_b64 exec, s[76:77]
    buffer_store_dword v41, v14, s[36:39], 0 offen
    s_mov_b64 exec, -1
K1_NOX_D_0:
    v_add_u32 v14, 64, v14
    v_fma_f32 v36, -v248, v24, v188
    v_fma_f32 v37, -v249, v24, v189
    v_fma_f32 v38, -v250, v24, v190
    v_fma_f32 v39, -v251, v24, v191
    v_mul_f32 v36, v36, v252
    v_mul_f32 v37, v37, v253
    v_mul_f32 v38, v38, v254
    v_mul_f32 v39, v39, v255
    v_add_f32 v40, v36, v37
    v_add_f32 v41, v38, v39
    v_add_f32 v33, v40, v41
    v_sub_f32 v35, v40, v41
    v_cvt_pk_bf16_f32 v44, v32, v33
    v_cvt_pk_bf16_f32 v45, v34, v35
    v_fma_f32 v36, -v240, v25, v192
    v_fma_f32 v37, -v241, v25, v193
    v_fma_f32 v38, -v242, v25, v194
    v_fma_f32 v39, -v243, v25, v195
    v_mul_f32 v36, v36, v244
    v_mul_f32 v37, v37, v245
    v_mul_f32 v38, v38, v246
    v_mul_f32 v39, v39, v247
    v_add_f32 v40, v36, v37
    v_add_f32 v41, v38, v39
    v_add_f32 v32, v40, v41
    v_sub_f32 v34, v40, v41
    v_sub_f32 v42, v36, v37
    v_cndmask_b32 v32, v32, v40, s[76:77]
    v_cndmask_b32 v34, v34, v42, s[76:77]
    s_cmp_eq_u32 s76, 0
    s_cbranch_scc1 K1_NOX_D_1
    s_mov_b64 exec, s[76:77]
    buffer_store_dword v41, v14, s[36:39], 0 offen
    s_mov_b64 exec, -1
K1_NOX_D_1:
    v_add_u32 v14, 64, v14
    v_fma_f32 v36, -v248, v25, v196
    v_fma_f32 v37, -v249, v25, v197
    v_fma_f32 v38, -v250, v25, v198
    v_fma_f32 v39, -v251, v25, v199
    v_mul_f32 v36, v36, v252
    v_mul_f32 v37, v37, v253
    v_mul_f32 v38, v38, v254
    v_mul_f32 v39, v39, v255
    v_add_f32 v40, v36, v37
    v_add_f32 v41, v38, v39
    v_add_f32 v33, v40, v41
    v_sub_f32 v35, v40, v41
    v_cvt_pk_bf16_f32 v46, v32, v33
    v_cvt_pk_bf16_f32 v47, v34, v35
    s_nop 1
    v_permlane32_swap_b32 v44, v46
    v_permlane32_swap_b32 v45, v47
    s_nop 1
    v_permlane16_swap_b32 v44, v45
    v_permlane16_swap_b32 v46, v47
    buffer_store_dwordx4 v[44:47], v13, s[36:39], s67 offen sc1
    s_lshl_b32 s66, s65, 5
    s_add_u32 s67, s67, s66
    v_fma_f32 v228, -v240, v26, v200
    v_fma_f32 v229, -v241, v26, v201
    v_fma_f32 v230, -v242, v26, v202
    v_fma_f32 v231, -v243, v26, v203
    v_mul_f32 v228, v228, v244
    v_mul_f32 v229, v229, v245
    v_mul_f32 v230, v230, v246
    v_mul_f32 v231, v231, v247
    v_add_f32 v232, v228, v229
    v_add_f32 v233, v230, v231
    v_add_f32 v224, v232, v233
    v_sub_f32 v226, v232, v233
    v_sub_f32 v234, v228, v229
    v_cndmask_b32 v224, v224, v232, s[76:77]
    v_cndmask_b32 v226, v226, v234, s[76:77]
    s_cmp_eq_u32 s76, 0
    s_cbranch_scc1 K1_NOX_D_2
    s_mov_b64 exec, s[76:77]
    buffer_store_dword v233, v14, s[36:39], 0 offen
    s_mov_b64 exec, -1
K1_NOX_D_2:
    v_add_u32 v14, 64, v14
    v_fma_f32 v228, -v248, v26, v204
    v_fma_f32 v229, -v249, v26, v205
    v_fma_f32 v230, -v250, v26, v206
    v_fma_f32 v231, -v251, v26, v207
    v_mul_f32 v228, v228, v252
    v_mul_f32 v229, v229, v253
    v_mul_f32 v230, v230, v254
    v_mul_f32 v231, v231, v255
    v_add_f32 v232, v228, v229
    v_add_f32 v233, v230, v231
    v_add_f32 v225, v232, v233
    v_sub_f32 v227, v232, v233
    v_cvt_pk_bf16_f32 v236, v224, v225
    v_cvt_pk_bf16_f32 v237, v226, v227
    v_fma_f32 v228, -v240, v27, v208
    v_fma_f32 v229, -v241, v27, v209
    v_fma_f32 v230, -v242, v27, v210
    v_fma_f32 v231, -v243, v27, v211
    v_mul_f32 v228, v228, v244
    v_mul_f32 v229, v229, v245
    v_mul_f32 v230, v230, v246
    v_mul_f32 v231, v231, v247
    v_add_f32 v232, v228, v229
    v_add_f32 v233, v230, v231
    v_add_f32 v224, v232, v233
    v_sub_f32 v226, v232, v233
    v_sub_f32 v234, v228, v229
    v_cndmask_b32 v224, v224, v232, s[76:77]
    v_cndmask_b32 v226, v226, v234, s[76:77]
    s_cmp_eq_u32 s76, 0
    s_cbranch_scc1 K1_NOX_D_3
    s_mov_b64 exec, s[76:77]
    buffer_store_dword v233, v14, s[36:39], 0 offen
    s_mov_b64 exec, -1
K1_NOX_D_3:
    v_add_u32 v14, 64, v14
    v_fma_f32 v228, -v248, v27, v212
    v_fma_f32 v229, -v249, v27, v213
    v_fma_f32 v230, -v250, v27, v214
    v_fma_f32 v231, -v251, v27, v215
    v_mul_f32 v228, v228, v252
    v_mul_f32 v229, v229, v253
    v_mul_f32 v230, v230, v254
    v_mul_f32 v231, v231, v255
    v_add_f32 v232, v228, v229
    v_add_f32 v233, v230, v231
    v_add_f32 v225, v232, v233
    v_sub_f32 v227, v232, v233
    v_cvt_pk_bf16_f32 v238, v224, v225
    v_cvt_pk_bf16_f32 v239, v226, v227
    s_nop 1
    v_permlane32_swap_b32 v236, v238
    v_permlane32_swap_b32 v237, v239
    s_nop 1
    v_permlane16_swap_b32 v236, v237
    v_permlane16_swap_b32 v238, v239
    buffer_store_dwordx4 v[236:239], v13, s[36:39], s67 offen sc1
    s_lshl_b32 s66, s65, 5
    s_add_u32 s67, s67, s66
    v_lshl_add_u32 v16, s53, 4, v2
    v_cmp_eq_u32 vcc, 0, v16
    s_lshl_b32 s66, s53, 14
    s_add_u32 s66, s66, 0xcc000
    v_mov_b32 v18, 0x44000
    v_mul_lo_u32 v18, v18, v3
    v_sub_u32 v17, s66, v18
    v_add_u32 v18, 0x40000, v18
    v_cndmask_b32 v17, v17, v18, vcc
    v_lshl_add_u32 v17, v2, 4, v17
    v_mov_b32 v18, -1.0
    v_cndmask_b32 v18, v18, 1.0, vcc
    v_add_u32 v22, 288, v16
    v_mov_b32 v23, 0x100
    v_cndmask_b32 v22, v22, v23, vcc
    v_lshlrev_b32 v22, 2, v22
    v_add_u32 v22, 0xb10000, v22
    v_mul_f32 v92, v216, v244
    v_mul_f32 v93, v217, v245
    v_mul_f32 v94, v218, v246
    v_mul_f32 v95, v219, v247
    v_fma_f32 v96, v18, v93, v92
    v_fma_f32 v97, v18, v95, v94
    v_add_f32 v88, v96, v97
    v_sub_f32 v90, v96, v97
    v_sub_f32 v98, v92, v93
    v_cndmask_b32 v98, 0, v98, vcc
    v_cndmask_b32 v99, 0, v96, vcc
    v_cndmask_b32 v88, v88, v99, s[76:77]
    v_cndmask_b32 v90, v90, v98, s[76:77]
    s_cmp_eq_u32 s76, 0
    s_cbranch_scc1 K1_NOX_D_g
    s_mov_b64 exec, s[76:77]
    buffer_store_dword v97, v22, s[36:39], 0 offen
    s_mov_b64 exec, -1
K1_NOX_D_g:
    v_mul_f32 v92, v220, v252
    v_mul_f32 v93, v221, v253
    v_mul_f32 v94, v222, v254
    v_mul_f32 v95, v223, v255
    v_fma_f32 v96, v18, v93, v92
    v_fma_f32 v97, v18, v95, v94
    v_add_f32 v89, v96, v97
    v_sub_f32 v91, v96, v97
    v_cvt_pk_bf16_f32 v100, v88, v89
    v_cvt_pk_bf16_f32 v101, v90, v91
    s_nop 1
    v_permlane32_swap_b32 v100, v102
    v_permlane32_swap_b32 v101, v103
    s_nop 1
    v_permlane16_swap_b32 v100, v101
    v_permlane16_swap_b32 v102, v103
    s_mov_b32 exec_hi, 0
    buffer_store_dwordx4 v[100:103], v17, s[36:39], s64 offen sc1
    s_mov_b32 exec_hi, -1
    s_endpgm
K1_PB_D:
    ds_read_b64_tr_b16 v[32:33], v4 offset:0
    ds_read_b64_tr_b16 v[34:35], v4 offset:512
    ds_read_b64_tr_b16 v[36:37], v5 offset:0
    ds_read_b64_tr_b16 v[38:39], v5 offset:512
    ds_read_b64_tr_b16 v[40:41], v6 offset:0
    ds_read_b64_tr_b16 v[42:43], v6 offset:512
    ds_read_b64_tr_b16 v[44:45], v7 offset:0
    ds_read_b64_tr_b16 v[46:47], v7 offset:512
    ds_read_b64_tr_b16 v[48:49], v224 offset:0
    ds_read_b64_tr_b16 v[50:51], v224 offset:512
    ds_read_b64_tr_b16 v[52:53], v225 offset:0
    ds_read_b64_tr_b16 v[54:55], v225 offset:512
    ds_read_b64_tr_b16 v[228:229], v226 offset:0
    ds_read_b64_tr_b16 v[230:231], v226 offset:512
    s_waitcnt lgkmcnt(12)
    v_mfma_f32_16x16x32_bf16 v[184:187], v[56:59], v[32:35], 0
    ds_read_b64_tr_b16 v[232:233], v227 offset:0
    v_mfma_f32_16x16x32_bf16 v[188:191], v[60:63], v[32:35], 0
    ds_read_b64_tr_b16 v[234:235], v227 offset:512
    v_mfma_f32_16x16x32_bf16 v[216:219], v[240:243], v[32:35], 0
    s_waitcnt lgkmcnt(12)
    v_mfma_f32_16x16x32_bf16 v[192:195], v[56:59], v[36:39], 0
    ds_read_b64_tr_b16 v[236:237], v4 offset:8192
    v_mfma_f32_16x16x32_bf16 v[196:199], v[60:63], v[36:39], 0
    ds_read_b64_tr_b16 v[238:239], v4 offset:8704
    v_mfma_f32_16x16x32_bf16 v[220:223], v[240:243], v[36:39], 0
    s_waitcnt lgkmcnt(12)
    v_mfma_f32_16x16x32_bf16 v[200:203], v[56:59], v[40:43], 0
    ds_read_b64_tr_b16 v[32:33], v5 offset:8192
    v_mfma_f32_16x16x32_bf16 v[204:207], v[60:63], v[40:43], 0
    ds_read_b64_tr_b16 v[34:35], v5 offset:8704
    s_waitcnt lgkmcnt(12)
    v_mfma_f32_16x16x32_bf16 v[208:211], v[56:59], v[44:47], 0
    ds_read_b64_tr_b16 v[36:37], v6 offset:8192
    v_mfma_f32_16x16x32_bf16 v[212:215], v[60:63], v[44:47], 0
    ds_read_b64_tr_b16 v[38:39], v6 offset:8704
    s_waitcnt lgkmcnt(12)
    v_mfma_f32_16x16x32_bf16 v[184:187], v[64:67], v[48:51], v[184:187]
    ds_read_b64_tr_b16 v[40:41], v7 offset:8192
    v_mfma_f32_16x16x32_bf16 v[188:191], v[68:71], v[48:51], v[188:191]
    ds_read_b64_tr_b16 v[42:43], v7 offset:8704
    s_waitcnt lgkmcnt(12)
    v_mfma_f32_16x16x32_bf16 v[192:195], v[64:67], v[52:55], v[192:195]
    ds_read_b64_tr_b16 v[44:45], v224 offset:8192
    v_mfma_f32_16x16x32_bf16 v[196:199], v[68:71], v[52:55], v[196:199]
    ds_read_b64_tr_b16 v[46:47], v224 offset:8704
    s_waitcnt lgkmcnt(12)
    v_mfma_f32_16x16x32_bf16 v[200:203], v[64:67], v[228:231], v[200:203]
    ds_read_b64_tr_b16 v[48:49], v225 offset:8192
    v_mfma_f32_16x16x32_bf16 v[204:207], v[68:71], v[228:231], v[204:207]
    ds_read_b64_tr_b16 v[50:51], v225 offset:8704
    s_waitcnt lgkmcnt(12)
    v_mfma_f32_16x16x32_bf16 v[208:211], v[64:67], v[232:235], v[208:211]
    ds_read_b64_tr_b16 v[52:53], v226 offset:8192
    v_mfma_f32_16x16x32_bf16 v[212:215], v[68:71], v[232:235], v[212:215]
    ds_read_b64_tr_b16 v[54:55], v226 offset:8704
    s_waitcnt lgkmcnt(12)
    v_mfma_f32_16x16x32_bf16 v[184:187], v[72:75], v[236:239], v[184:187]
    ds_read_b64_tr_b16 v[228:229], v227 offset:8192
    v_mfma_f32_16x16x32_bf16 v[188:191], v[76:79], v[236:239], v[188:191]
    ds_read_b64_tr_b16 v[230:231], v227 offset:8704
    v_mfma_f32_16x16x32_bf16 v[216:219], v[240:243], v[236:239], v[216:219]
    s_waitcnt lgkmcnt(12)
    v_mfma_f32_16x16x32_bf16 v[192:195], v[72:75], v[32:35], v[192:195]
    ds_read_b64_tr_b16 v[232:233], v4 offset:16384
    v_mfma_f32_16x16x32_bf16 v[196:199], v[76:79], v[32:35], v[196:199]
    ds_read_b64_tr_b16 v[234:235], v4 offset:16896
    v_mfma_f32_16x16x32_bf16 v[220:223], v[240:243], v[32:35], v[220:223]
    s_waitcnt lgkmcnt(12)
    v_mfma_f32_16x16x32_bf16 v[200:203], v[72:75], v[36:39], v[200:203]
    ds_read_b64_tr_b16 v[236:237], v5 offset:16384
    v_mfma_f32_16x16x32_bf16 v[204:207], v[76:79], v[36:39], v[204:207]
    ds_read_b64_tr_b16 v[238:239], v5 offset:16896
    s_waitcnt lgkmcnt(12)
    v_mfma_f32_16x16x32_bf16 v[208:211], v[72:75], v[40:43], v[208:211]
    ds_read_b64_tr_b16 v[32:33], v6 offset:16384
    v_mfma_f32_16x16x32_bf16 v[212:215], v[76:79], v[40:43], v[212:215]
    ds_read_b64_tr_b16 v[34:35], v6 offset:16896
    s_waitcnt lgkmcnt(12)
    v_mfma_f32_16x16x32_bf16 v[184:187], v[80:83], v[44:47], v[184:187]
    ds_read_b64_tr_b16 v[36:37], v7 offset:16384
    v_mfma_f32_16x16x32_bf16 v[188:191], v[84:87], v[44:47], v[188:191]
    ds_read_b64_tr_b16 v[38:39], v7 offset:16896
    s_waitcnt lgkmcnt(12)
    v_mfma_f32_16x16x32_bf16 v[192:195], v[80:83], v[48:51], v[192:195]
    ds_read_b64_tr_b16 v[40:41], v224 offset:16384
    v_mfma_f32_16x16x32_bf16 v[196:199], v[84:87], v[48:51], v[196:199]
    ds_read_b64_tr_b16 v[42:43], v224 offset:16896
    s_waitcnt lgkmcnt(12)
    v_mfma_f32_16x16x32_bf16 v[200:203], v[80:83], v[52:55], v[200:203]
    ds_read_b64_tr_b16 v[44:45], v225 offset:16384
    v_mfma_f32_16x16x32_bf16 v[204:207], v[84:87], v[52:55], v[204:207]
    ds_read_b64_tr_b16 v[46:47], v225 offset:16896
    s_waitcnt lgkmcnt(12)
    v_mfma_f32_16x16x32_bf16 v[208:211], v[80:83], v[228:231], v[208:211]
    ds_read_b64_tr_b16 v[48:49], v226 offset:16384
    v_mfma_f32_16x16x32_bf16 v[212:215], v[84:87], v[228:231], v[212:215]
    ds_read_b64_tr_b16 v[50:51], v226 offset:16896
    s_waitcnt lgkmcnt(12)
    v_mfma_f32_16x16x32_bf16 v[184:187], v[88:91], v[232:235], v[184:187]
    ds_read_b64_tr_b16 v[52:53], v227 offset:16384
    v_mfma_f32_16x16x32_bf16 v[188:191], v[92:95], v[232:235], v[188:191]
    ds_read_b64_tr_b16 v[54:55], v227 offset:16896
    v_mfma_f32_16x16x32_bf16 v[216:219], v[240:243], v[232:235], v[216:219]
    s_waitcnt lgkmcnt(12)
    v_mfma_f32_16x16x32_bf16 v[192:195], v[88:91], v[236:239], v[192:195]
    ds_read_b64_tr_b16 v[228:229], v4 offset:24576
    v_mfma_f32_16x16x32_bf16 v[196:199], v[92:95], v[236:239], v[196:199]
    ds_read_b64_tr_b16 v[230:231], v4 offset:25088
    v_mfma_f32_16x16x32_bf16 v[220:223], v[240:243], v[236:239], v[220:223]
    s_waitcnt lgkmcnt(12)
    s_waitcnt vmcnt(2)
    v_mov_b32 v18, 155648
    v_mov_b32 v19, 1
    s_mov_b64 exec, 1
    ds_add_u32 v18, v19 offset:2048
    s_mov_b64 exec, -1
    v_mfma_f32_16x16x32_bf16 v[200:203], v[88:91], v[32:35], v[200:203]
    ds_read_b64_tr_b16 v[232:233], v5 offset:24576
    v_mfma_f32_16x16x32_bf16 v[204:207], v[92:95], v[32:35], v[204:207]
    ds_read_b64_tr_b16 v[234:235], v5 offset:25088
    s_waitcnt lgkmcnt(13)
    v_mfma_f32_16x16x32_bf16 v[208:211], v[88:91], v[36:39], v[208:211]
    ds_read_b64_tr_b16 v[236:237], v6 offset:24576
    v_mfma_f32_16x16x32_bf16 v[212:215], v[92:95], v[36:39], v[212:215]
    ds_read_b64_tr_b16 v[238:239], v6 offset:25088
    s_waitcnt lgkmcnt(13)
    v_mfma_f32_16x16x32_bf16 v[184:187], v[96:99], v[40:43], v[184:187]
    ds_read_b64_tr_b16 v[32:33], v7 offset:24576
    v_mfma_f32_16x16x32_bf16 v[188:191], v[100:103], v[40:43], v[188:191]
    ds_read_b64_tr_b16 v[34:35], v7 offset:25088
    s_waitcnt lgkmcnt(13)
    v_mfma_f32_16x16x32_bf16 v[192:195], v[96:99], v[44:47], v[192:195]
    ds_read_b64_tr_b16 v[36:37], v224 offset:24576
    v_mfma_f32_16x16x32_bf16 v[196:199], v[100:103], v[44:47], v[196:199]
    ds_read_b64_tr_b16 v[38:39], v224 offset:25088
    s_waitcnt lgkmcnt(13)
    v_mfma_f32_16x16x32_bf16 v[200:203], v[96:99], v[48:51], v[200:203]
    ds_read_b64_tr_b16 v[40:41], v225 offset:24576
    v_mfma_f32_16x16x32_bf16 v[204:207], v[100:103], v[48:51], v[204:207]
    ds_read_b64_tr_b16 v[42:43], v225 offset:25088
    s_waitcnt lgkmcnt(13)
    v_mfma_f32_16x16x32_bf16 v[208:211], v[96:99], v[52:55], v[208:211]
    ds_read_b64_tr_b16 v[44:45], v226 offset:24576
    v_mfma_f32_16x16x32_bf16 v[212:215], v[100:103], v[52:55], v[212:215]
    ds_read_b64_tr_b16 v[46:47], v226 offset:25088
    s_waitcnt lgkmcnt(13)
    v_mfma_f32_16x16x32_bf16 v[184:187], v[104:107], v[228:231], v[184:187]
    ds_read_b64_tr_b16 v[48:49], v227 offset:24576
    v_mfma_f32_16x16x32_bf16 v[188:191], v[108:111], v[228:231], v[188:191]
    ds_read_b64_tr_b16 v[50:51], v227 offset:25088
    v_mfma_f32_16x16x32_bf16 v[216:219], v[240:243], v[228:231], v[216:219]
    v_subrev_u32 v4, 49152, v4
    v_subrev_u32 v5, 49152, v5
    v_subrev_u32 v6, 49152, v6
    v_subrev_u32 v7, 49152, v7
    v_subrev_u32 v224, 49152, v224
    v_subrev_u32 v225, 49152, v225
    v_subrev_u32 v226, 49152, v226
    v_subrev_u32 v227, 49152, v227
    s_waitcnt lgkmcnt(8)
K1_SPIN_D_0:
    ds_read_b32 v19, v18 offset:2048
    s_waitcnt lgkmcnt(0)
    v_readfirstlane_b32 s72, v19
    s_cmp_lt_u32 s72, 4
    s_cbranch_scc1 K1_SPIN_D_0
    v_mfma_f32_16x16x32_bf16 v[192:195], v[104:107], v[232:235], v[192:195]
    ds_read_b64_tr_b16 v[52:53], v4 offset:0
    v_mfma_f32_16x16x32_bf16 v[196:199], v[108:111], v[232:235], v[196:199]
    ds_read_b64_tr_b16 v[54:55], v4 offset:512
    v_mfma_f32_16x16x32_bf16 v[220:223], v[240:243], v[232:235], v[220:223]
    v_mfma_f32_16x16x32_bf16 v[200:203], v[104:107], v[236:239], v[200:203]
    ds_read_b64_tr_b16 v[228:229], v5 offset:0
    v_mfma_f32_16x16x32_bf16 v[204:207], v[108:111], v[236:239], v[204:207]
    ds_read_b64_tr_b16 v[230:231], v5 offset:512
    v_mfma_f32_16x16x32_bf16 v[208:211], v[104:107], v[32:35], v[208:211]
    ds_read_b64_tr_b16 v[232:233], v224 offset:0
    v_mfma_f32_16x16x32_bf16 v[212:215], v[108:111], v[32:35], v[212:215]
    ds_read_b64_tr_b16 v[234:235], v224 offset:512
    v_mfma_f32_16x16x32_bf16 v[184:187], v[112:115], v[36:39], v[184:187]
    ds_read_b64_tr_b16 v[236:237], v225 offset:0
    v_mfma_f32_16x16x32_bf16 v[188:191], v[116:119], v[36:39], v[188:191]
    ds_read_b64_tr_b16 v[238:239], v225 offset:512
    v_mfma_f32_16x16x32_bf16 v[192:195], v[112:115], v[40:43], v[192:195]
    ds_read_b64_tr_b16 v[32:33], v4 offset:8192
    v_mfma_f32_16x16x32_bf16 v[196:199], v[116:119], v[40:43], v[196:199]
    ds_read_b64_tr_b16 v[34:35], v4 offset:8704
    v_mfma_f32_16x16x32_bf16 v[200:203], v[112:115], v[44:47], v[200:203]
    ds_read_b64_tr_b16 v[36:37], v5 offset:8192
    v_mfma_f32_16x16x32_bf16 v[204:207], v[116:119], v[44:47], v[204:207]
    ds_read_b64_tr_b16 v[38:39], v5 offset:8704
    v_mfma_f32_16x16x32_bf16 v[208:211], v[112:115], v[48:51], v[208:211]
    ds_read_b64_tr_b16 v[40:41], v224 offset:8192
    v_mfma_f32_16x16x32_bf16 v[212:215], v[116:119], v[48:51], v[212:215]
    ds_read_b64_tr_b16 v[42:43], v224 offset:8704
    s_waitcnt lgkmcnt(12)
    v_mfma_f32_16x16x32_bf16 v[184:187], v[120:123], v[52:55], v[184:187]
    ds_read_b64_tr_b16 v[44:45], v225 offset:8192
    v_mfma_f32_16x16x32_bf16 v[188:191], v[124:127], v[52:55], v[188:191]
    ds_read_b64_tr_b16 v[46:47], v225 offset:8704
    v_mfma_f32_16x16x32_bf16 v[216:219], v[240:243], v[52:55], v[216:219]
    s_waitcnt lgkmcnt(12)
    v_mfma_f32_16x16x32_bf16 v[192:195], v[120:123], v[228:231], v[192:195]
    ds_read_b64_tr_b16 v[48:49], v4 offset:16384
    v_mfma_f32_16x16x32_bf16 v[196:199], v[124:127], v[228:231], v[196:199]
    ds_read_b64_tr_b16 v[50:51], v4 offset:16896
    v_mfma_f32_16x16x32_bf16 v[220:223], v[240:243], v[228:231], v[220:223]
    s_waitcnt lgkmcnt(12)
    v_mfma_f32_16x16x32_bf16 v[184:187], v[128:131], v[232:235], v[184:187]
    ds_read_b64_tr_b16 v[52:53], v5 offset:16384
    v_mfma_f32_16x16x32_bf16 v[188:191], v[132:135], v[232:235], v[188:191]
    ds_read_b64_tr_b16 v[54:55], v5 offset:16896
    s_waitcnt lgkmcnt(12)
    v_mfma_f32_16x16x32_bf16 v[192:195], v[128:131], v[236:239], v[192:195]
    ds_read_b64_tr_b16 v[228:229], v224 offset:16384
    v_mfma_f32_16x16x32_bf16 v[196:199], v[132:135], v[236:239], v[196:199]
    ds_read_b64_tr_b16 v[230:231], v224 offset:16896
    s_waitcnt lgkmcnt(12)
    v_mfma_f32_16x16x32_bf16 v[184:187], v[136:139], v[32:35], v[184:187]
    ds_read_b64_tr_b16 v[232:233], v225 offset:16384
    v_mfma_f32_16x16x32_bf16 v[188:191], v[140:143], v[32:35], v[188:191]
    ds_read_b64_tr_b16 v[234:235], v225 offset:16896
    v_mfma_f32_16x16x32_bf16 v[216:219], v[240:243], v[32:35], v[216:219]
    s_waitcnt lgkmcnt(12)
    v_mfma_f32_16x16x32_bf16 v[192:195], v[136:139], v[36:39], v[192:195]
    ds_read_b64_tr_b16 v[236:237], v4 offset:24576
    v_mfma_f32_16x16x32_bf16 v[196:199], v[140:143], v[36:39], v[196:199]
    ds_read_b64_tr_b16 v[238:239], v4 offset:25088
    v_mfma_f32_16x16x32_bf16 v[220:223], v[240:243], v[36:39], v[220:223]
    s_waitcnt lgkmcnt(12)
    v_mfma_f32_16x16x32_bf16 v[184:187], v[144:147], v[40:43], v[184:187]
    ds_read_b64_tr_b16 v[32:33], v5 offset:24576
    v_mfma_f32_16x16x32_bf16 v[188:191], v[148:151], v[40:43], v[188:191]
    ds_read_b64_tr_b16 v[34:35], v5 offset:25088
    s_waitcnt lgkmcnt(12)
    v_mfma_f32_16x16x32_bf16 v[192:195], v[144:147], v[44:47], v[192:195]
    ds_read_b64_tr_b16 v[36:37], v224 offset:24576
    v_mfma_f32_16x16x32_bf16 v[196:199], v[148:151], v[44:47], v[196:199]
    ds_read_b64_tr_b16 v[38:39], v224 offset:25088
    s_waitcnt lgkmcnt(12)
    v_mfma_f32_16x16x32_bf16 v[184:187], v[152:155], v[48:51], v[184:187]
    ds_read_b64_tr_b16 v[40:41], v225 offset:24576
    v_mfma_f32_16x16x32_bf16 v[188:191], v[156:159], v[48:51], v[188:191]
    ds_read_b64_tr_b16 v[42:43], v225 offset:25088
    v_mfma_f32_16x16x32_bf16 v[216:219], v[240:243], v[48:51], v[216:219]
    s_waitcnt lgkmcnt(12)
    v_mfma_f32_16x16x32_bf16 v[192:195], v[152:155], v[52:55], v[192:195]
    ds_read_b64_tr_b16 v[44:45], v6 offset:0
    v_mfma_f32_16x16x32_bf16 v[196:199], v[156:159], v[52:55], v[196:199]
    ds_read_b64_tr_b16 v[46:47], v6 offset:512
    v_mfma_f32_16x16x32_bf16 v[220:223], v[240:243], v[52:55], v[220:223]
    s_waitcnt lgkmcnt(12)
    v_mfma_f32_16x16x32_bf16 v[184:187], v[160:163], v[228:231], v[184:187]
    ds_read_b64_tr_b16 v[48:49], v7 offset:0
    v_mfma_f32_16x16x32_bf16 v[188:191], v[164:167], v[228:231], v[188:191]
    ds_read_b64_tr_b16 v[50:51], v7 offset:512
    s_waitcnt lgkmcnt(12)
    v_mfma_f32_16x16x32_bf16 v[192:195], v[160:163], v[232:235], v[192:195]
    ds_read_b64_tr_b16 v[52:53], v226 offset:0
    v_mfma_f32_16x16x32_bf16 v[196:199], v[164:167], v[232:235], v[196:199]
    ds_read_b64_tr_b16 v[54:55], v226 offset:512
    s_waitcnt lgkmcnt(12)
    v_mfma_f32_16x16x32_bf16 v[184:187], v[168:171], v[236:239], v[184:187]
    ds_read_b64_tr_b16 v[228:229], v227 offset:0
    v_mfma_f32_16x16x32_bf16 v[188:191], v[172:175], v[236:239], v[188:191]
    ds_read_b64_tr_b16 v[230:231], v227 offset:512
    v_mfma_f32_16x16x32_bf16 v[216:219], v[240:243], v[236:239], v[216:219]
    s_waitcnt lgkmcnt(12)
    v_mfma_f32_16x16x32_bf16 v[192:195], v[168:171], v[32:35], v[192:195]
    ds_read_b64_tr_b16 v[232:233], v6 offset:8192
    v_mfma_f32_16x16x32_bf16 v[196:199], v[172:175], v[32:35], v[196:199]
    ds_read_b64_tr_b16 v[234:235], v6 offset:8704
    v_mfma_f32_16x16x32_bf16 v[220:223], v[240:243], v[32:35], v[220:223]
    s_waitcnt lgkmcnt(12)
    v_mfma_f32_16x16x32_bf16 v[184:187], v[176:179], v[36:39], v[184:187]
    ds_read_b64_tr_b16 v[236:237], v7 offset:8192
    v_mfma_f32_16x16x32_bf16 v[188:191], v[180:183], v[36:39], v[188:191]
    ds_read_b64_tr_b16 v[238:239], v7 offset:8704
    s_waitcnt lgkmcnt(8)
    s_mov_b64 exec, 0xffff
    ds_add_f32 v10, v216 offset:256
    ds_add_f32 v10, v220 offset:320
    s_mov_b64 exec, -1
    v_mov_b32 v18, 155648
    v_mov_b32 v19, 1
    s_mov_b64 exec, 1
    ds_add_u32 v18, v19 offset:2112
    s_mov_b64 exec, -1
    v_mfma_f32_16x16x32_bf16 v[192:195], v[176:179], v[40:43], v[192:195]
    ds_read_b64_tr_b16 v[32:33], v226 offset:8192
    v_mfma_f32_16x16x32_bf16 v[196:199], v[180:183], v[40:43], v[196:199]
    ds_read_b64_tr_b16 v[34:35], v226 offset:8704
    v_mfma_f32_16x16x32_bf16 v[200:203], v[120:123], v[44:47], v[200:203]
    ds_read_b64_tr_b16 v[36:37], v227 offset:8192
    v_mfma_f32_16x16x32_bf16 v[204:207], v[124:127], v[44:47], v[204:207]
    ds_read_b64_tr_b16 v[38:39], v227 offset:8704
    s_waitcnt lgkmcnt(9)
    v_add_u32 v20, s63, v12
    ds_read_b128 v[240:243], v20 offset:512
    ds_read_b128 v[244:247], v20 offset:1024
    ds_read_b128 v[248:251], v20 offset:576
    ds_read_b128 v[252:255], v20 offset:1088
    s_waitcnt lgkmcnt(8)
K1_SPIN_D_1:
    ds_read_b32 v19, v18 offset:2112
    s_waitcnt lgkmcnt(0)
    v_readfirstlane_b32 s72, v19
    s_cmp_lt_u32 s72, 4
    s_cbranch_scc1 K1_SPIN_D_1
    v_xor_b32 v23, 0x80, v10
    ds_read_b32 v24, v10 offset:256
    ds_read_b32 v25, v10 offset:320
    ds_read_b32 v26, v23 offset:256
    ds_read_b32 v27, v23 offset:320
    v_mfma_f32_16x16x32_bf16 v[208:211], v[120:123], v[48:51], v[208:211]
    ds_read_b64_tr_b16 v[40:41], v6 offset:16384
    v_mfma_f32_16x16x32_bf16 v[212:215], v[124:127], v[48:51], v[212:215]
    ds_read_b64_tr_b16 v[42:43], v6 offset:16896
    v_mfma_f32_16x16x32_bf16 v[200:203], v[128:131], v[52:55], v[200:203]
    ds_read_b64_tr_b16 v[44:45], v7 offset:16384
    v_mfma_f32_16x16x32_bf16 v[204:207], v[132:135], v[52:55], v[204:207]
    ds_read_b64_tr_b16 v[46:47], v7 offset:16896
    v_mfma_f32_16x16x32_bf16 v[208:211], v[128:131], v[228:231], v[208:211]
    ds_read_b64_tr_b16 v[48:49], v226 offset:16384
    v_mfma_f32_16x16x32_bf16 v[212:215], v[132:135], v[228:231], v[212:215]
    ds_read_b64_tr_b16 v[50:51], v226 offset:16896
    s_waitcnt lgkmcnt(6)
    v_mfma_f32_16x16x32_bf16 v[200:203], v[136:139], v[232:235], v[200:203]
    ds_read_b64_tr_b16 v[52:53], v227 offset:16384
    v_mfma_f32_16x16x32_bf16 v[204:207], v[140:143], v[232:235], v[204:207]
    ds_read_b64_tr_b16 v[54:55], v227 offset:16896
    v_fma_f32 v76, -v240, v24, v184
    v_fma_f32 v77, -v241, v24, v185
    v_fma_f32 v78, -v242, v24, v186
    v_fma_f32 v79, -v243, v24, v187
    v_mul_f32 v76, v76, v244
    v_mul_f32 v77, v77, v245
    v_mfma_f32_16x16x32_bf16 v[208:211], v[136:139], v[236:239], v[208:211]
    ds_read_b64_tr_b16 v[228:229], v6 offset:24576
    v_mfma_f32_16x16x32_bf16 v[212:215], v[140:143], v[236:239], v[212:215]
    ds_read_b64_tr_b16 v[230:231], v6 offset:25088
    v_mul_f32 v78, v78, v246
    v_mul_f32 v79, v79, v247
    v_add_f32 v80, v76, v77
    v_add_f32 v81, v78, v79
    v_add_f32 v72, v80, v81
    v_sub_f32 v74, v80, v81
    v_mfma_f32_16x16x32_bf16 v[200:203], v[144:147], v[32:35], v[200:203]
    ds_read_b64_tr_b16 v[232:233], v7 offset:24576
    v_mfma_f32_16x16x32_bf16 v[204:207], v[148:151], v[32:35], v[204:207]
    ds_read_b64_tr_b16 v[234:235], v7 offset:25088
    v_sub_f32 v82, v76, v77
    v_cndmask_b32 v72, v72, v80, s[76:77]
    v_cndmask_b32 v74, v74, v82, s[76:77]
    s_cmp_eq_u32 s76, 0
    s_cbranch_scc1 K1_NOX_D_4
    s_mov_b64 exec, s[76:77]
    buffer_store_dword v81, v14, s[36:39], 0 offen
    s_mov_b64 exec, -1
K1_NOX_D_4:
    v_add_u32 v14, 64, v14
    v_fma_f32 v76, -v248, v24, v188
    v_mfma_f32_16x16x32_bf16 v[208:211], v[144:147], v[36:39], v[208:211]
    ds_read_b64_tr_b16 v[236:237], v226 offset:24576
    v_mfma_f32_16x16x32_bf16 v[212:215], v[148:151], v[36:39], v[212:215]
    ds_read_b64_tr_b16 v[238:239], v226 offset:25088
    v_fma_f32 v77, -v249, v24, v189
    v_fma_f32 v78, -v250, v24, v190
    v_fma_f32 v79, -v251, v24, v191
    v_mul_f32 v76, v76, v252
    v_mul_f32 v77, v77, v253
    v_mul_f32 v78, v78, v254
    s_waitcnt lgkmcnt(12)
    v_mfma_f32_16x16x32_bf16 v[200:203], v[152:155], v[40:43], v[200:203]
    ds_read_b64_tr_b16 v[32:33], v227 offset:24576
    v_mfma_f32_16x16x32_bf16 v[204:207], v[156:159], v[40:43], v[204:207]
    ds_read_b64_tr_b16 v[34:35], v227 offset:25088
    v_mul_f32 v79, v79, v255
    v_add_f32 v80, v76, v77
    v_add_f32 v81, v78, v79
    v_add_f32 v73, v80, v81
    v_sub_f32 v75, v80, v81
    v_cvt_pk_bf16_f32 v84, v72, v73
    s_waitcnt lgkmcnt(12)
    v_mfma_f32_16x16x32_bf16 v[208:211], v[152:155], v[44:47], v[208:211]
    v_mfma_f32_16x16x32_bf16 v[212:215], v[156:159], v[44:47], v[212:215]
    v_cvt_pk_bf16_f32 v85, v74, v75
    v_fma_f32 v76, -v240, v25, v192
    v_fma_f32 v77, -v241, v25, v193
    v_fma_f32 v78, -v242, v25, v194
    v_fma_f32 v79, -v243, v25, v195
    v_mul_f32 v76, v76, v244
    s_waitcnt lgkmcnt(10)
    v_mfma_f32_16x16x32_bf16 v[200:203], v[160:163], v[48:51], v[200:203]
    v_mfma_f32_16x16x32_bf16 v[204:207], v[164:167], v[48:51], v[204:207]
    v_mul_f32 v77, v77, v245
    v_mul_f32 v78, v78, v246
    v_mul_f32 v79, v79, v247
    v_add_f32 v80, v76, v77
    v_add_f32 v81, v78, v79
    v_add_f32 v72, v80, v81
    s_waitcnt lgkmcnt(8)
    v_mfma_f32_16x16x32_bf16 v[208:211], v[160:163], v[52:55], v[208:211]
    v_mfma_f32_16x16x32_bf16 v[212:215], v[164:167], v[52:55], v[212:215]
    v_sub_f32 v74, v80, v81
    v_sub_f32 v82, v76, v77
    v_cndmask_b32 v72, v72, v80, s[76:77]
    v_cndmask_b32 v74, v74, v82, s[76:77]
    s_cmp_eq_u32 s76, 0
    s_cbranch_scc1 K1_NOX_D_5
    s_mov_b64 exec, s[76:77]
    buffer_store_dword v81, v14, s[36:39], 0 offen
    s_mov_b64 exec, -1
K1_NOX_D_5:
    v_add_u32 v14, 64, v14
    s_waitcnt lgkmcnt(6)
    v_mfma_f32_16x16x32_bf16 v[200:203], v[168:171], v[228:231], v[200:203]
    v_mfma_f32_16x16x32_bf16 v[204:207], v[172:175], v[228:231], v[204:207]
    v_fma_f32 v76, -v248, v25, v196
    v_fma_f32 v77, -v249, v25, v197
    v_fma_f32 v78, -v250, v25, v198
    v_fma_f32 v79, -v251, v25, v199
    v_mul_f32 v76, v76, v252
    v_mul_f32 v77, v77, v253
    s_waitcnt lgkmcnt(4)
    v_mfma_f32_16x16x32_bf16 v[208:211], v[168:171], v[232:235], v[208:211]
    v_mfma_f32_16x16x32_bf16 v[212:215], v[172:175], v[232:235], v[212:215]
    v_mul_f32 v78, v78, v254
    v_mul_f32 v79, v79, v255
    v_add_f32 v80, v76, v77
    v_add_f32 v81, v78, v79
    v_add_f32 v73, v80, v81
    v_sub_f32 v75, v80, v81
    s_waitcnt lgkmcnt(2)
    v_mfma_f32_16x16x32_bf16 v[200:203], v[176:179], v[236:239], v[200:203]
    v_mfma_f32_16x16x32_bf16 v[204:207], v[180:183], v[236:239], v[204:207]
    v_cvt_pk_bf16_f32 v86, v72, v73
    v_cvt_pk_bf16_f32 v87, v74, v75
    s_nop 1
    v_permlane32_swap_b32 v84, v86
    v_permlane32_swap_b32 v85, v87
    s_nop 1
    s_waitcnt lgkmcnt(0)
    v_mfma_f32_16x16x32_bf16 v[208:211], v[176:179], v[32:35], v[208:211]
    v_mfma_f32_16x16x32_bf16 v[212:215], v[180:183], v[32:35], v[212:215]
    v_permlane16_swap_b32 v84, v85
    v_permlane16_swap_b32 v86, v87
    buffer_store_dwordx4 v[84:87], v13, s[36:39], s67 offen sc1
    s_lshl_b32 s66, s65, 5
    s_add_u32 s67, s67, s66
    s_waitcnt lgkmcnt(0)
    s_nop 5
    v_fma_f32 v100, -v240, v26, v200
    v_fma_f32 v101, -v241, v26, v201
    v_fma_f32 v102, -v242, v26, v202
    v_fma_f32 v103, -v243, v26, v203
    v_mul_f32 v100, v100, v244
    v_mul_f32 v101, v101, v245
    v_mul_f32 v102, v102, v246
    v_mul_f32 v103, v103, v247
    v_add_f32 v104, v100, v101
    v_add_f32 v105, v102, v103
    v_add_f32 v96, v104, v105
    v_sub_f32 v98, v104, v105
    v_sub_f32 v106, v100, v101
    v_cndmask_b32 v96, v96, v104, s[76:77]
    v_cndmask_b32 v98, v98, v106, s[76:77]
    s_cmp_eq_u32 s76, 0
    s_cbranch_scc1 K1_NOX_D_6
    s_mov_b64 exec, s[76:77]
    buffer_store_dword v105, v14, s[36:39], 0 offen
    s_mov_b64 exec, -1
K1_NOX_D_6:
    v_add_u32 v14, 64, v14
    v_fma_f32 v100, -v248, v26, v204
    v_fma_f32 v101, -v249, v26, v205
    v_fma_f32 v102, -v250, v26, v206
    v_fma_f32 v103, -v251, v26, v207
    v_mul_f32 v100, v100, v252
    v_mul_f32 v101, v101, v253
    v_mul_f32 v102, v102, v254
    v_mul_f32 v103, v103, v255
    v_add_f32 v104, v100, v101
    v_add_f32 v105, v102, v103
    v_add_f32 v97, v104, v105
    v_sub_f32 v99, v104, v105
    v_cvt_pk_bf16_f32 v108, v96, v97
    v_cvt_pk_bf16_f32 v109, v98, v99
    v_fma_f32 v100, -v240, v27, v208
    v_fma_f32 v101, -v241, v27, v209
    v_fma_f32 v102, -v242, v27, v210
    v_fma_f32 v103, -v243, v27, v211
    v_mul_f32 v100, v100, v244
    v_mul_f32 v101, v101, v245
    v_mul_f32 v102, v102, v246
    v_mul_f32 v103, v103, v247
    v_add_f32 v104, v100, v101
    v_add_f32 v105, v102, v103
    v_add_f32 v96, v104, v105
    v_sub_f32 v98, v104, v105
    v_sub_f32 v106, v100, v101
    v_cndmask_b32 v96, v96, v104, s[76:77]
    v_cndmask_b32 v98, v98, v106, s[76:77]
    s_cmp_eq_u32 s76, 0
    s_cbranch_scc1 K1_NOX_D_7
    s_mov_b64 exec, s[76:77]
    buffer_store_dword v105, v14, s[36:39], 0 offen
    s_mov_b64 exec, -1
K1_NOX_D_7:
    v_add_u32 v14, 64, v14
    v_fma_f32 v100, -v248, v27, v212
    v_fma_f32 v101, -v249, v27, v213
    v_fma_f32 v102, -v250, v27, v214
    v_fma_f32 v103, -v251, v27, v215
    v_mul_f32 v100, v100, v252
    v_mul_f32 v101, v101, v253
    v_mul_f32 v102, v102, v254
    v_mul_f32 v103, v103, v255
    v_add_f32 v104, v100, v101
    v_add_f32 v105, v102, v103
    v_add_f32 v97, v104, v105
    v_sub_f32 v99, v104, v105
    v_cvt_pk_bf16_f32 v110, v96, v97
    v_cvt_pk_bf16_f32 v111, v98, v99
    s_nop 1
    v_permlane32_swap_b32 v108, v110
    v_permlane32_swap_b32 v109, v111
    s_nop 1
    v_permlane16_swap_b32 v108, v109
    v_permlane16_swap_b32 v110, v111
    buffer_store_dwordx4 v[108:111], v13, s[36:39], s67 offen sc1
    s_lshl_b32 s66, s65, 5
    s_add_u32 s67, s67, s66
    s_endpgm
K1_END:
    s_endpgm
.globl k2_kernel
.p2align 8
.type k2_kernel,@function
k2_kernel:
    s_cmp_ge_u32 s2, 256
    s_cbranch_scc1 K2_END
    s_load_dwordx16 s[4:19], s[0:1], 0
    s_load_dwordx8 s[20:27], s[0:1], 64
    s_load_dwordx2 s[28:29], s[0:1], 96
    v_lshrrev_b32 v1, 6, v0
    v_and_b32 v2, 15, v0
    v_readfirstlane_b32 s54, v1
    v_and_b32 v1, 63, v0
    v_lshrrev_b32 v3, 4, v1
    v_lshlrev_b32 v4, 4, v1
    s_getpc_b64 s[30:31]
K2_PC:
    v_lshlrev_b32 v30, 7, v0
    v_min_u32 v31, CODE_END-K2_PC-4, v30
    global_load_dword v0, v31, s[30:31]
    s_waitcnt lgkmcnt(0)
    s_mov_b32 s36, s28
    s_and_b32 s37, s29, 0xffff
    s_mov_b32 s38, 0xb12000
    s_mov_b32 s39, 0x00020000
    s_and_b32 s56, s2, 1
    s_and_b32 s52, s2, 6
    s_lshl_b32 s52, s52, 1
    s_bfe_u32 s55, s2, 0x20003
    s_add_u32 s52, s52, s55
    s_lshr_b32 s53, s2, 5
    s_lshl_b32 s57, s52, 5
    s_add_u32 s57, s57, s56
    s_cmp_eq_u32 s54, 3
    s_cbranch_scc1 K2_DFT
    s_lshl_b32 s60, s52, 1
    s_add_u32 s60, s60, s56
    s_mul_i32 s60, s60, 233472
    s_add_u32 s61, s60, 0
    v_add_u32 v26, s61, v4
    s_add_u32 s61, s60, 58368
    v_add_u32 v27, s61, v4
    s_add_u32 s61, s60, 116736
    v_add_u32 v28, s61, v4
    s_add_u32 s61, s60, 175104
    v_add_u32 v29, s61, v4
    s_mul_i32 s62, s53, 116736
    s_add_u32 s61, s62, 0x800000
    v_add_u32 v22, s61, v4
    v_add_u32 v23, 0xe400, v22
    s_sub_u32 s61, 0x9ab800, s62
    v_add_u32 v24, s61, v4
    v_add_u32 v25, 0xe400, v24
    s_mul_i32 s68, s54, 19456
    s_and_b32 s69, s2, 7
    s_mul_i32 s69, s69, 7168
    s_add_u32 s68, s68, s69
    s_sub_u32 s68, s68, 0x400
    s_add_u32 s68, s68, 0x400
    s_sub_u32 s69, s68, 57344
    s_cmp_ge_u32 s68, 57344
    s_cselect_b32 s68, s69, s68
    buffer_load_dwordx4 v[120:123], v22, s[36:39], s68 offen offset:0
    buffer_load_dwordx4 v[136:139], v26, s[36:39], s68 offen offset:0
    buffer_load_dwordx4 v[124:127], v23, s[36:39], s68 offen offset:0
    buffer_load_dwordx4 v[140:143], v27, s[36:39], s68 offen offset:0
    buffer_load_dwordx4 v[128:131], v24, s[36:39], s68 offen offset:0
    buffer_load_dwordx4 v[144:147], v28, s[36:39], s68 offen offset:0
    buffer_load_dwordx4 v[132:135], v25, s[36:39], s68 offen offset:0
    buffer_load_dwordx4 v[148:151], v29, s[36:39], s68 offen offset:0
    s_add_u32 s68, s68, 0x400
    s_sub_u32 s69, s68, 57344
    s_cmp_ge_u32 s68, 57344
    s_cselect_b32 s68, s69, s68
    buffer_load_dwordx4 v[152:155], v22, s[36:39], s68 offen offset:0
    buffer_load_dwordx4 v[168:171], v26, s[36:39], s68 offen offset:0
    buffer_load_dwordx4 v[156:159], v23, s[36:39], s68 offen offset:0
    buffer_load_dwordx4 v[172:175], v27, s[36:39], s68 offen offset:0
    buffer_load_dwordx4 v[160:163], v24, s[36:39], s68 offen offset:0
    buffer_load_dwordx4 v[176:179], v28, s[36:39], s68 offen offset:0
    buffer_load_dwordx4 v[164:167], v25, s[36:39], s68 offen offset:0
    buffer_load_dwordx4 v[180:183], v29, s[36:39], s68 offen offset:0
    s_mov_b32 s32, s4
    s_and_b32 s33, s5, 0xffff
    s_mov_b32 s34, 0x200000
    s_mov_b32 s35, 0x00020000
    s_mov_b32 s40, s22
    s_and_b32 s41, s23, 0xffff
    s_mov_b32 s42, 0x400
    s_mov_b32 s43, 0x00020000
    s_mov_b32 s60, s24
    s_and_b32 s61, s25, 0xffff
    s_mov_b32 s62, 0x200000
    s_mov_b32 s63, 0x00020000
    v_bfe_u32 v30, v1, 2, 2
    v_mov_b32 v31, 0x400
    v_cmp_eq_u32 vcc, 0, v30
    v_add_u32 v34, 1, v30
    v_and_b32 v34, 2, v34
    v_cndmask_b32 v31, v31, 0, vcc
    v_sub_u32 v32, 1, v34
    v_cmp_eq_u32 vcc, 1, v30
    v_mov_b32 v34, 0x800
    v_and_b32 v33, 1, v30
    v_cndmask_b32 v31, v31, v34, vcc
    v_lshlrev_b32 v33, 10, v33
    v_lshrrev_b32 v34, 1, v30
    v_lshl_add_u32 v33, v34, 9, v33
    s_lshl_b32 s66, s54, 3
    s_add_u32 s66, s66, s57
    v_lshl_add_u32 v34, v3, 1, s66
    v_mad_i32_i24 v35, v32, v34, v31
    v_cmp_eq_u32 vcc, 0, v34
    v_and_b32 v36, 3, v1
    v_lshlrev_b32 v36, 4, v36
    v_cndmask_b32 v35, v35, v33, vcc
    v_lshl_add_u32 v5, v35, 10, v36
    s_lshl_b32 s64, s53, 6
    s_sub_u32 s65, 960, s64
    buffer_load_dwordx4 v[6:9], v5, s[32:35], s64 offen
    buffer_load_dwordx4 v[10:13], v5, s[32:35], s65 offen
    buffer_load_dwordx4 v[14:17], v36, s[40:43], s64 offen
    buffer_load_dwordx4 v[18:21], v36, s[40:43], s65 offen
    s_add_u32 s68, s68, 0x400
    s_sub_u32 s69, s68, 57344
    s_cmp_ge_u32 s68, 57344
    s_cselect_b32 s68, s69, s68
    buffer_load_dwordx4 v[184:187], v22, s[36:39], s68 offen offset:0
    buffer_load_dwordx4 v[200:203], v26, s[36:39], s68 offen offset:0
    buffer_load_dwordx4 v[188:191], v23, s[36:39], s68 offen offset:0
    buffer_load_dwordx4 v[204:207], v27, s[36:39], s68 offen offset:0
    buffer_load_dwordx4 v[192:195], v24, s[36:39], s68 offen offset:0
    buffer_load_dwordx4 v[208:211], v28, s[36:39], s68 offen offset:0
    buffer_load_dwordx4 v[196:199], v25, s[36:39], s68 offen offset:0
    buffer_load_dwordx4 v[212:215], v29, s[36:39], s68 offen offset:0
    s_add_u32 s68, s68, 0x400
    s_sub_u32 s69, s68, 57344
    s_cmp_ge_u32 s68, 57344
    s_cselect_b32 s68, s69, s68
    buffer_load_dwordx4 v[216:219], v22, s[36:39], s68 offen offset:0
    buffer_load_dwordx4 v[232:235], v26, s[36:39], s68 offen offset:0
    buffer_load_dwordx4 v[220:223], v23, s[36:39], s68 offen offset:0
    buffer_load_dwordx4 v[236:239], v27, s[36:39], s68 offen offset:0
    buffer_load_dwordx4 v[224:227], v24, s[36:39], s68 offen offset:0
    buffer_load_dwordx4 v[240:243], v28, s[36:39], s68 offen offset:0
    buffer_load_dwordx4 v[228:231], v25, s[36:39], s68 offen offset:0
    buffer_load_dwordx4 v[244:247], v29, s[36:39], s68 offen offset:0
    s_add_u32 s68, s68, 0x400
    s_sub_u32 s69, s68, 57344
    s_cmp_ge_u32 s68, 57344
    s_cselect_b32 s68, s69, s68
    buffer_load_dwordx4 a[0:3], v22, s[36:39], s68 offen offset:0
    buffer_load_dwordx4 a[16:19], v26, s[36:39], s68 offen offset:0
    buffer_load_dwordx4 a[4:7], v23, s[36:39], s68 offen offset:0
    buffer_load_dwordx4 a[20:23], v27, s[36:39], s68 offen offset:0
    buffer_load_dwordx4 a[8:11], v24, s[36:39], s68 offen offset:0
    buffer_load_dwordx4 a[24:27], v28, s[36:39], s68 offen offset:0
    buffer_load_dwordx4 a[12:15], v25, s[36:39], s68 offen offset:0
    buffer_load_dwordx4 a[28:31], v29, s[36:39], s68 offen offset:0
    s_add_u32 s68, s68, 0x400
    s_sub_u32 s69, s68, 57344
    s_cmp_ge_u32 s68, 57344
    s_cselect_b32 s68, s69, s68
    buffer_load_dwordx4 a[32:35], v22, s[36:39], s68 offen offset:0
    buffer_load_dwordx4 a[48:51], v26, s[36:39], s68 offen offset:0
    buffer_load_dwordx4 a[36:39], v23, s[36:39], s68 offen offset:0
    buffer_load_dwordx4 a[52:55], v27, s[36:39], s68 offen offset:0
    buffer_load_dwordx4 a[40:43], v24, s[36:39], s68 offen offset:0
    buffer_load_dwordx4 a[56:59], v28, s[36:39], s68 offen offset:0
    buffer_load_dwordx4 a[44:47], v25, s[36:39], s68 offen offset:0
    buffer_load_dwordx4 a[60:63], v29, s[36:39], s68 offen offset:0
    s_add_u32 s68, s68, 0x400
    s_sub_u32 s69, s68, 57344
    s_cmp_ge_u32 s68, 57344
    s_cselect_b32 s68, s69, s68
    buffer_load_dwordx4 a[64:67], v22, s[36:39], s68 offen offset:0
    buffer_load_dwordx4 a[80:83], v26, s[36:39], s68 offen offset:0
    buffer_load_dwordx4 a[68:71], v23, s[36:39], s68 offen offset:0
    buffer_load_dwordx4 a[84:87], v27, s[36:39], s68 offen offset:0
    buffer_load_dwordx4 a[72:75], v24, s[36:39], s68 offen offset:0
    buffer_load_dwordx4 a[88:91], v28, s[36:39], s68 offen offset:0
    buffer_load_dwordx4 a[76:79], v25, s[36:39], s68 offen offset:0
    buffer_load_dwordx4 a[92:95], v29, s[36:39], s68 offen offset:0
    s_add_u32 s68, s68, 0x400
    s_sub_u32 s69, s68, 57344
    s_cmp_ge_u32 s68, 57344
    s_cselect_b32 s68, s69, s68
    buffer_load_dwordx4 a[96:99], v22, s[36:39], s68 offen offset:0
    buffer_load_dwordx4 a[112:115], v26, s[36:39], s68 offen offset:0
    buffer_load_dwordx4 a[100:103], v23, s[36:39], s68 offen offset:0
    buffer_load_dwordx4 a[116:119], v27, s[36:39], s68 offen offset:0
    buffer_load_dwordx4 a[104:107], v24, s[36:39], s68 offen offset:0
    buffer_load_dwordx4 a[120:123], v28, s[36:39], s68 offen offset:0
    buffer_load_dwordx4 a[108:111], v25, s[36:39], s68 offen offset:0
    buffer_load_dwordx4 a[124:127], v29, s[36:39], s68 offen offset:0
    s_waitcnt vmcnt(60)
    v_mfma_f32_16x16x32_bf16 v[48:51], v[120:123], v[136:139], 0
    v_mfma_f32_16x16x32_bf16 v[52:55], v[120:123], v[140:143], 0
    v_mfma_f32_16x16x32_bf16 v[56:59], v[120:123], v[144:147], 0
    v_mfma_f32_16x16x32_bf16 v[60:63], v[120:123], v[148:151], 0
    v_mfma_f32_16x16x32_bf16 v[64:67], v[124:127], v[136:139], 0
    v_mfma_f32_16x16x32_bf16 v[68:71], v[124:127], v[140:143], 0
    v_mfma_f32_16x16x32_bf16 v[72:75], v[124:127], v[144:147], 0
    v_mfma_f32_16x16x32_bf16 v[76:79], v[124:127], v[148:151], 0
    v_mfma_f32_16x16x32_bf16 v[80:83], v[128:131], v[136:139], 0
    v_mfma_f32_16x16x32_bf16 v[84:87], v[128:131], v[140:143], 0
    v_mfma_f32_16x16x32_bf16 v[88:91], v[128:131], v[144:147], 0
    v_mfma_f32_16x16x32_bf16 v[92:95], v[128:131], v[148:151], 0
    v_mfma_f32_16x16x32_bf16 v[96:99], v[132:135], v[136:139], 0
    v_mfma_f32_16x16x32_bf16 v[100:103], v[132:135], v[140:143], 0
    v_mfma_f32_16x16x32_bf16 v[104:107], v[132:135], v[144:147], 0
    v_mfma_f32_16x16x32_bf16 v[108:111], v[132:135], v[148:151], 0
    s_add_u32 s68, s68, 0x400
    s_sub_u32 s69, s68, 57344
    s_cmp_ge_u32 s68, 57344
    s_cselect_b32 s68, s69, s68
    buffer_load_dwordx4 v[120:123], v22, s[36:39], s68 offen offset:0
    buffer_load_dwordx4 v[136:139], v26, s[36:39], s68 offen offset:0
    buffer_load_dwordx4 v[124:127], v23, s[36:39], s68 offen offset:0
    buffer_load_dwordx4 v[140:143], v27, s[36:39], s68 offen offset:0
    buffer_load_dwordx4 v[128:131], v24, s[36:39], s68 offen offset:0
    buffer_load_dwordx4 v[144:147], v28, s[36:39], s68 offen offset:0
    buffer_load_dwordx4 v[132:135], v25, s[36:39], s68 offen offset:0
    buffer_load_dwordx4 v[148:151], v29, s[36:39], s68 offen offset:0
    s_waitcnt vmcnt(60)
    v_mfma_f32_16x16x32_bf16 v[48:51], v[152:155], v[168:171], v[48:51]
    v_mfma_f32_16x16x32_bf16 v[52:55], v[152:155], v[172:175], v[52:55]
    v_mfma_f32_16x16x32_bf16 v[56:59], v[152:155], v[176:179], v[56:59]
    v_mfma_f32_16x16x32_bf16 v[60:63], v[152:155], v[180:183], v[60:63]
    v_mfma_f32_16x16x32_bf16 v[64:67], v[156:159], v[168:171], v[64:67]
    v_mfma_f32_16x16x32_bf16 v[68:71], v[156:159], v[172:175], v[68:71]
    v_mfma_f32_16x16x32_bf16 v[72:75], v[156:159], v[176:179], v[72:75]
    v_mfma_f32_16x16x32_bf16 v[76:79], v[156:159], v[180:183], v[76:79]
    v_mfma_f32_16x16x32_bf16 v[80:83], v[160:163], v[168:171], v[80:83]
    v_mfma_f32_16x16x32_bf16 v[84:87], v[160:163], v[172:175], v[84:87]
    v_mfma_f32_16x16x32_bf16 v[88:91], v[160:163], v[176:179], v[88:91]
    v_mfma_f32_16x16x32_bf16 v[92:95], v[160:163], v[180:183], v[92:95]
    v_mfma_f32_16x16x32_bf16 v[96:99], v[164:167], v[168:171], v[96:99]
    v_mfma_f32_16x16x32_bf16 v[100:103], v[164:167], v[172:175], v[100:103]
    v_mfma_f32_16x16x32_bf16 v[104:107], v[164:167], v[176:179], v[104:107]
    v_mfma_f32_16x16x32_bf16 v[108:111], v[164:167], v[180:183], v[108:111]
    s_add_u32 s68, s68, 0x400
    s_sub_u32 s69, s68, 57344
    s_cmp_ge_u32 s68, 57344
    s_cselect_b32 s68, s69, s68
    buffer_load_dwordx4 v[152:155], v22, s[36:39], s68 offen offset:0
    buffer_load_dwordx4 v[168:171], v26, s[36:39], s68 offen offset:0
    buffer_load_dwordx4 v[156:159], v23, s[36:39], s68 offen offset:0
    buffer_load_dwordx4 v[172:175], v27, s[36:39], s68 offen offset:0
    buffer_load_dwordx4 v[160:163], v24, s[36:39], s68 offen offset:0
    buffer_load_dwordx4 v[176:179], v28, s[36:39], s68 offen offset:0
    buffer_load_dwordx4 v[164:167], v25, s[36:39], s68 offen offset:0
    buffer_load_dwordx4 v[180:183], v29, s[36:39], s68 offen offset:0
    s_waitcnt vmcnt(56)
    v_mfma_f32_16x16x32_bf16 v[48:51], v[184:187], v[200:203], v[48:51]
    v_mfma_f32_16x16x32_bf16 v[52:55], v[184:187], v[204:207], v[52:55]
    v_mfma_f32_16x16x32_bf16 v[56:59], v[184:187], v[208:211], v[56:59]
    v_mfma_f32_16x16x32_bf16 v[60:63], v[184:187], v[212:215], v[60:63]
    v_mfma_f32_16x16x32_bf16 v[64:67], v[188:191], v[200:203], v[64:67]
    v_mfma_f32_16x16x32_bf16 v[68:71], v[188:191], v[204:207], v[68:71]
    v_mfma_f32_16x16x32_bf16 v[72:75], v[188:191], v[208:211], v[72:75]
    v_mfma_f32_16x16x32_bf16 v[76:79], v[188:191], v[212:215], v[76:79]
    v_mfma_f32_16x16x32_bf16 v[80:83], v[192:195], v[200:203], v[80:83]
    v_mfma_f32_16x16x32_bf16 v[84:87], v[192:195], v[204:207], v[84:87]
    v_mfma_f32_16x16x32_bf16 v[88:91], v[192:195], v[208:211], v[88:91]
    v_mfma_f32_16x16x32_bf16 v[92:95], v[192:195], v[212:215], v[92:95]
    v_mfma_f32_16x16x32_bf16 v[96:99], v[196:199], v[200:203], v[96:99]
    v_mfma_f32_16x16x32_bf16 v[100:103], v[196:199], v[204:207], v[100:103]
    v_mfma_f32_16x16x32_bf16 v[104:107], v[196:199], v[208:211], v[104:107]
    v_mfma_f32_16x16x32_bf16 v[108:111], v[196:199], v[212:215], v[108:111]
    s_add_u32 s68, s68, 0x400
    s_sub_u32 s69, s68, 57344
    s_cmp_ge_u32 s68, 57344
    s_cselect_b32 s68, s69, s68
    buffer_load_dwordx4 v[184:187], v22, s[36:39], s68 offen offset:0
    buffer_load_dwordx4 v[200:203], v26, s[36:39], s68 offen offset:0
    buffer_load_dwordx4 v[188:191], v23, s[36:39], s68 offen offset:0
    buffer_load_dwordx4 v[204:207], v27, s[36:39], s68 offen offset:0
    buffer_load_dwordx4 v[192:195], v24, s[36:39], s68 offen offset:0
    buffer_load_dwordx4 v[208:211], v28, s[36:39], s68 offen offset:0
    buffer_load_dwordx4 v[196:199], v25, s[36:39], s68 offen offset:0
    buffer_load_dwordx4 v[212:215], v29, s[36:39], s68 offen offset:0
    s_waitcnt vmcnt(56)
    v_mfma_f32_16x16x32_bf16 v[48:51], v[216:219], v[232:235], v[48:51]
    v_mfma_f32_16x16x32_bf16 v[52:55], v[216:219], v[236:239], v[52:55]
    v_mfma_f32_16x16x32_bf16 v[56:59], v[216:219], v[240:243], v[56:59]
    v_mfma_f32_16x16x32_bf16 v[60:63], v[216:219], v[244:247], v[60:63]
    v_mfma_f32_16x16x32_bf16 v[64:67], v[220:223], v[232:235], v[64:67]
    v_mfma_f32_16x16x32_bf16 v[68:71], v[220:223], v[236:239], v[68:71]
    v_mfma_f32_16x16x32_bf16 v[72:75], v[220:223], v[240:243], v[72:75]
    v_mfma_f32_16x16x32_bf16 v[76:79], v[220:223], v[244:247], v[76:79]
    v_mfma_f32_16x16x32_bf16 v[80:83], v[224:227], v[232:235], v[80:83]
    v_mfma_f32_16x16x32_bf16 v[84:87], v[224:227], v[236:239], v[84:87]
    v_mfma_f32_16x16x32_bf16 v[88:91], v[224:227], v[240:243], v[88:91]
    v_mfma_f32_16x16x32_bf16 v[92:95], v[224:227], v[244:247], v[92:95]
    v_mfma_f32_16x16x32_bf16 v[96:99], v[228:231], v[232:235], v[96:99]
    v_mfma_f32_16x16x32_bf16 v[100:103], v[228:231], v[236:239], v[100:103]
    v_mfma_f32_16x16x32_bf16 v[104:107], v[228:231], v[240:243], v[104:107]
    v_mfma_f32_16x16x32_bf16 v[108:111], v[228:231], v[244:247], v[108:111]
    s_add_u32 s68, s68, 0x400
    s_sub_u32 s69, s68, 57344
    s_cmp_ge_u32 s68, 57344
    s_cselect_b32 s68, s69, s68
    buffer_load_dwordx4 v[216:219], v22, s[36:39], s68 offen offset:0
    buffer_load_dwordx4 v[232:235], v26, s[36:39], s68 offen offset:0
    buffer_load_dwordx4 v[220:223], v23, s[36:39], s68 offen offset:0
    buffer_load_dwordx4 v[236:239], v27, s[36:39], s68 offen offset:0
    buffer_load_dwordx4 v[224:227], v24, s[36:39], s68 offen offset:0
    buffer_load_dwordx4 v[240:243], v28, s[36:39], s68 offen offset:0
    buffer_load_dwordx4 v[228:231], v25, s[36:39], s68 offen offset:0
    buffer_load_dwordx4 v[244:247], v29, s[36:39], s68 offen offset:0
    s_waitcnt vmcnt(56)
    v_mfma_f32_16x16x32_bf16 v[48:51], a[0:3], a[16:19], v[48:51]
    v_mfma_f32_16x16x32_bf16 v[52:55], a[0:3], a[20:23], v[52:55]
    v_mfma_f32_16x16x32_bf16 v[56:59], a[0:3], a[24:27], v[56:59]
    v_mfma_f32_16x16x32_bf16 v[60:63], a[0:3], a[28:31], v[60:63]
    v_mfma_f32_16x16x32_bf16 v[64:67], a[4:7], a[16:19], v[64:67]
    v_mfma_f32_16x16x32_bf16 v[68:71], a[4:7], a[20:23], v[68:71]
    v_mfma_f32_16x16x32_bf16 v[72:75], a[4:7], a[24:27], v[72:75]
    v_mfma_f32_16x16x32_bf16 v[76:79], a[4:7], a[28:31], v[76:79]
    v_mfma_f32_16x16x32_bf16 v[80:83], a[8:11], a[16:19], v[80:83]
    v_mfma_f32_16x16x32_bf16 v[84:87], a[8:11], a[20:23], v[84:87]
    v_mfma_f32_16x16x32_bf16 v[88:91], a[8:11], a[24:27], v[88:91]
    v_mfma_f32_16x16x32_bf16 v[92:95], a[8:11], a[28:31], v[92:95]
    v_mfma_f32_16x16x32_bf16 v[96:99], a[12:15], a[16:19], v[96:99]
    v_mfma_f32_16x16x32_bf16 v[100:103], a[12:15], a[20:23], v[100:103]
    v_mfma_f32_16x16x32_bf16 v[104:107], a[12:15], a[24:27], v[104:107]
    v_mfma_f32_16x16x32_bf16 v[108:111], a[12:15], a[28:31], v[108:111]
    s_add_u32 s68, s68, 0x400
    s_sub_u32 s69, s68, 57344
    s_cmp_ge_u32 s68, 57344
    s_cselect_b32 s68, s69, s68
    buffer_load_dwordx4 a[0:3], v22, s[36:39], s68 offen offset:0
    buffer_load_dwordx4 a[16:19], v26, s[36:39], s68 offen offset:0
    buffer_load_dwordx4 a[4:7], v23, s[36:39], s68 offen offset:0
    buffer_load_dwordx4 a[20:23], v27, s[36:39], s68 offen offset:0
    buffer_load_dwordx4 a[8:11], v24, s[36:39], s68 offen offset:0
    buffer_load_dwordx4 a[24:27], v28, s[36:39], s68 offen offset:0
    buffer_load_dwordx4 a[12:15], v25, s[36:39], s68 offen offset:0
    buffer_load_dwordx4 a[28:31], v29, s[36:39], s68 offen offset:0
    s_waitcnt vmcnt(56)
    v_mfma_f32_16x16x32_bf16 v[48:51], a[32:35], a[48:51], v[48:51]
    v_mfma_f32_16x16x32_bf16 v[52:55], a[32:35], a[52:55], v[52:55]
    v_mfma_f32_16x16x32_bf16 v[56:59], a[32:35], a[56:59], v[56:59]
    v_mfma_f32_16x16x32_bf16 v[60:63], a[32:35], a[60:63], v[60:63]
    v_mfma_f32_16x16x32_bf16 v[64:67], a[36:39], a[48:51], v[64:67]
    v_mfma_f32_16x16x32_bf16 v[68:71], a[36:39], a[52:55], v[68:71]
    v_mfma_f32_16x16x32_bf16 v[72:75], a[36:39], a[56:59], v[72:75]
    v_mfma_f32_16x16x32_bf16 v[76:79], a[36:39], a[60:63], v[76:79]
    v_mfma_f32_16x16x32_bf16 v[80:83], a[40:43], a[48:51], v[80:83]
    v_mfma_f32_16x16x32_bf16 v[84:87], a[40:43], a[52:55], v[84:87]
    v_mfma_f32_16x16x32_bf16 v[88:91], a[40:43], a[56:59], v[88:91]
    v_mfma_f32_16x16x32_bf16 v[92:95], a[40:43], a[60:63], v[92:95]
    v_mfma_f32_16x16x32_bf16 v[96:99], a[44:47], a[48:51], v[96:99]
    v_mfma_f32_16x16x32_bf16 v[100:103], a[44:47], a[52:55], v[100:103]
    v_mfma_f32_16x16x32_bf16 v[104:107], a[44:47], a[56:59], v[104:107]
    v_mfma_f32_16x16x32_bf16 v[108:111], a[44:47], a[60:63], v[108:111]
    s_add_u32 s68, s68, 0x400
    s_sub_u32 s69, s68, 57344
    s_cmp_ge_u32 s68, 57344
    s_cselect_b32 s68, s69, s68
    buffer_load_dwordx4 a[32:35], v22, s[36:39], s68 offen offset:0
    buffer_load_dwordx4 a[48:51], v26, s[36:39], s68 offen offset:0
    buffer_load_dwordx4 a[36:39], v23, s[36:39], s68 offen offset:0
    buffer_load_dwordx4 a[52:55], v27, s[36:39], s68 offen offset:0
    buffer_load_dwordx4 a[40:43], v24, s[36:39], s68 offen offset:0
    buffer_load_dwordx4 a[56:59], v28, s[36:39], s68 offen offset:0
    buffer_load_dwordx4 a[44:47], v25, s[36:39], s68 offen offset:0
    buffer_load_dwordx4 a[60:63], v29, s[36:39], s68 offen offset:0
    s_waitcnt vmcnt(56)
    v_mfma_f32_16x16x32_bf16 v[48:51], a[64:67], a[80:83], v[48:51]
    v_mfma_f32_16x16x32_bf16 v[52:55], a[64:67], a[84:87], v[52:55]
    v_mfma_f32_16x16x32_bf16 v[56:59], a[64:67], a[88:91], v[56:59]
    v_mfma_f32_16x16x32_bf16 v[60:63], a[64:67], a[92:95], v[60:63]
    v_mfma_f32_16x16x32_bf16 v[64:67], a[68:71], a[80:83], v[64:67]
    v_mfma_f32_16x16x32_bf16 v[68:71], a[68:71], a[84:87], v[68:71]
    v_mfma_f32_16x16x32_bf16 v[72:75], a[68:71], a[88:91], v[72:75]
    v_mfma_f32_16x16x32_bf16 v[76:79], a[68:71], a[92:95], v[76:79]
    v_mfma_f32_16x16x32_bf16 v[80:83], a[72:75], a[80:83], v[80:83]
    v_mfma_f32_16x16x32_bf16 v[84:87], a[72:75], a[84:87], v[84:87]
    v_mfma_f32_16x16x32_bf16 v[88:91], a[72:75], a[88:91], v[88:91]
    v_mfma_f32_16x16x32_bf16 v[92:95], a[72:75], a[92:95], v[92:95]
    v_mfma_f32_16x16x32_bf16 v[96:99], a[76:79], a[80:83], v[96:99]
    v_mfma_f32_16x16x32_bf16 v[100:103], a[76:79], a[84:87], v[100:103]
    v_mfma_f32_16x16x32_bf16 v[104:107], a[76:79], a[88:91], v[104:107]
    v_mfma_f32_16x16x32_bf16 v[108:111], a[76:79], a[92:95], v[108:111]
    s_add_u32 s68, s68, 0x400
    s_sub_u32 s69, s68, 57344
    s_cmp_ge_u32 s68, 57344
    s_cselect_b32 s68, s69, s68
    buffer_load_dwordx4 a[64:67], v22, s[36:39], s68 offen offset:0
    buffer_load_dwordx4 a[80:83], v26, s[36:39], s68 offen offset:0
    buffer_load_dwordx4 a[68:71], v23, s[36:39], s68 offen offset:0
    buffer_load_dwordx4 a[84:87], v27, s[36:39], s68 offen offset:0
    buffer_load_dwordx4 a[72:75], v24, s[36:39], s68 offen offset:0
    buffer_load_dwordx4 a[88:91], v28, s[36:39], s68 offen offset:0
    buffer_load_dwordx4 a[76:79], v25, s[36:39], s68 offen offset:0
    buffer_load_dwordx4 a[92:95], v29, s[36:39], s68 offen offset:0
    s_waitcnt vmcnt(56)
    v_mfma_f32_16x16x32_bf16 v[48:51], a[96:99], a[112:115], v[48:51]
    v_mfma_f32_16x16x32_bf16 v[52:55], a[96:99], a[116:119], v[52:55]
    v_mfma_f32_16x16x32_bf16 v[56:59], a[96:99], a[120:123], v[56:59]
    v_mfma_f32_16x16x32_bf16 v[60:63], a[96:99], a[124:127], v[60:63]
    v_mfma_f32_16x16x32_bf16 v[64:67], a[100:103], a[112:115], v[64:67]
    v_mfma_f32_16x16x32_bf16 v[68:71], a[100:103], a[116:119], v[68:71]
    v_mfma_f32_16x16x32_bf16 v[72:75], a[100:103], a[120:123], v[72:75]
    v_mfma_f32_16x16x32_bf16 v[76:79], a[100:103], a[124:127], v[76:79]
    v_mfma_f32_16x16x32_bf16 v[80:83], a[104:107], a[112:115], v[80:83]
    v_mfma_f32_16x16x32_bf16 v[84:87], a[104:107], a[116:119], v[84:87]
    v_mfma_f32_16x16x32_bf16 v[88:91], a[104:107], a[120:123], v[88:91]
    v_mfma_f32_16x16x32_bf16 v[92:95], a[104:107], a[124:127], v[92:95]
    v_mfma_f32_16x16x32_bf16 v[96:99], a[108:111], a[112:115], v[96:99]
    v_mfma_f32_16x16x32_bf16 v[100:103], a[108:111], a[116:119], v[100:103]
    v_mfma_f32_16x16x32_bf16 v[104:107], a[108:111], a[120:123], v[104:107]
    v_mfma_f32_16x16x32_bf16 v[108:111], a[108:111], a[124:127], v[108:111]
    s_add_u32 s68, s68, 0x400
    s_sub_u32 s69, s68, 57344
    s_cmp_ge_u32 s68, 57344
    s_cselect_b32 s68, s69, s68
    buffer_load_dwordx4 a[96:99], v22, s[36:39], s68 offen offset:0
    buffer_load_dwordx4 a[112:115], v26, s[36:39], s68 offen offset:0
    buffer_load_dwordx4 a[100:103], v23, s[36:39], s68 offen offset:0
    buffer_load_dwordx4 a[116:119], v27, s[36:39], s68 offen offset:0
    buffer_load_dwordx4 a[104:107], v24, s[36:39], s68 offen offset:0
    buffer_load_dwordx4 a[120:123], v28, s[36:39], s68 offen offset:0
    buffer_load_dwordx4 a[108:111], v25, s[36:39], s68 offen offset:0
    buffer_load_dwordx4 a[124:127], v29, s[36:39], s68 offen offset:0
    s_waitcnt vmcnt(56)
    v_mfma_f32_16x16x32_bf16 v[48:51], v[120:123], v[136:139], v[48:51]
    v_mfma_f32_16x16x32_bf16 v[52:55], v[120:123], v[140:143], v[52:55]
    v_mfma_f32_16x16x32_bf16 v[56:59], v[120:123], v[144:147], v[56:59]
    v_mfma_f32_16x16x32_bf16 v[60:63], v[120:123], v[148:151], v[60:63]
    v_mfma_f32_16x16x32_bf16 v[64:67], v[124:127], v[136:139], v[64:67]
    v_mfma_f32_16x16x32_bf16 v[68:71], v[124:127], v[140:143], v[68:71]
    v_mfma_f32_16x16x32_bf16 v[72:75], v[124:127], v[144:147], v[72:75]
    v_mfma_f32_16x16x32_bf16 v[76:79], v[124:127], v[148:151], v[76:79]
    v_mfma_f32_16x16x32_bf16 v[80:83], v[128:131], v[136:139], v[80:83]
    v_mfma_f32_16x16x32_bf16 v[84:87], v[128:131], v[140:143], v[84:87]
    v_mfma_f32_16x16x32_bf16 v[88:91], v[128:131], v[144:147], v[88:91]
    v_mfma_f32_16x16x32_bf16 v[92:95], v[128:131], v[148:151], v[92:95]
    v_mfma_f32_16x16x32_bf16 v[96:99], v[132:135], v[136:139], v[96:99]
    v_mfma_f32_16x16x32_bf16 v[100:103], v[132:135], v[140:143], v[100:103]
    v_mfma_f32_16x16x32_bf16 v[104:107], v[132:135], v[144:147], v[104:107]
    v_mfma_f32_16x16x32_bf16 v[108:111], v[132:135], v[148:151], v[108:111]
    s_add_u32 s68, s68, 0x400
    s_sub_u32 s69, s68, 57344
    s_cmp_ge_u32 s68, 57344
    s_cselect_b32 s68, s69, s68
    buffer_load_dwordx4 v[120:123], v22, s[36:39], s68 offen offset:0
    buffer_load_dwordx4 v[136:139], v26, s[36:39], s68 offen offset:0
    buffer_load_dwordx4 v[124:127], v23, s[36:39], s68 offen offset:0
    buffer_load_dwordx4 v[140:143], v27, s[36:39], s68 offen offset:0
    buffer_load_dwordx4 v[128:131], v24, s[36:39], s68 offen offset:0
    buffer_load_dwordx4 v[144:147], v28, s[36:39], s68 offen offset:0
    buffer_load_dwordx4 v[132:135], v25, s[36:39], s68 offen offset:0
    buffer_load_dwordx4 v[148:151], v29, s[36:39], s68 offen offset:0
    s_waitcnt vmcnt(56)
    v_mfma_f32_16x16x32_bf16 v[48:51], v[152:155], v[168:171], v[48:51]
    v_mfma_f32_16x16x32_bf16 v[52:55], v[152:155], v[172:175], v[52:55]
    v_mfma_f32_16x16x32_bf16 v[56:59], v[152:155], v[176:179], v[56:59]
    v_mfma_f32_16x16x32_bf16 v[60:63], v[152:155], v[180:183], v[60:63]
    v_mfma_f32_16x16x32_bf16 v[64:67], v[156:159], v[168:171], v[64:67]
    v_mfma_f32_16x16x32_bf16 v[68:71], v[156:159], v[172:175], v[68:71]
    v_mfma_f32_16x16x32_bf16 v[72:75], v[156:159], v[176:179], v[72:75]
    v_mfma_f32_16x16x32_bf16 v[76:79], v[156:159], v[180:183], v[76:79]
    v_mfma_f32_16x16x32_bf16 v[80:83], v[160:163], v[168:171], v[80:83]
    v_mfma_f32_16x16x32_bf16 v[84:87], v[160:163], v[172:175], v[84:87]
    v_mfma_f32_16x16x32_bf16 v[88:91], v[160:163], v[176:179], v[88:91]
    v_mfma_f32_16x16x32_bf16 v[92:95], v[160:163], v[180:183], v[92:95]
    v_mfma_f32_16x16x32_bf16 v[96:99], v[164:167], v[168:171], v[96:99]
    v_mfma_f32_16x16x32_bf16 v[100:103], v[164:167], v[172:175], v[100:103]
    v_mfma_f32_16x16x32_bf16 v[104:107], v[164:167], v[176:179], v[104:107]
    v_mfma_f32_16x16x32_bf16 v[108:111], v[164:167], v[180:183], v[108:111]
    s_add_u32 s68, s68, 0x400
    s_sub_u32 s69, s68, 57344
    s_cmp_ge_u32 s68, 57344
    s_cselect_b32 s68, s69, s68
    buffer_load_dwordx4 v[152:155], v22, s[36:39], s68 offen offset:0
    buffer_load_dwordx4 v[168:171], v26, s[36:39], s68 offen offset:0
    buffer_load_dwordx4 v[156:159], v23, s[36:39], s68 offen offset:0
    buffer_load_dwordx4 v[172:175], v27, s[36:39], s68 offen offset:0
    buffer_load_dwordx4 v[160:163], v24, s[36:39], s68 offen offset:0
    buffer_load_dwordx4 v[176:179], v28, s[36:39], s68 offen offset:0
    buffer_load_dwordx4 v[164:167], v25, s[36:39], s68 offen offset:0
    buffer_load_dwordx4 v[180:183], v29, s[36:39], s68 offen offset:0
    s_waitcnt vmcnt(56)
    v_mfma_f32_16x16x32_bf16 v[48:51], v[184:187], v[200:203], v[48:51]
    v_mfma_f32_16x16x32_bf16 v[52:55], v[184:187], v[204:207], v[52:55]
    v_mfma_f32_16x16x32_bf16 v[56:59], v[184:187], v[208:211], v[56:59]
    v_mfma_f32_16x16x32_bf16 v[60:63], v[184:187], v[212:215], v[60:63]
    v_mfma_f32_16x16x32_bf16 v[64:67], v[188:191], v[200:203], v[64:67]
    v_mfma_f32_16x16x32_bf16 v[68:71], v[188:191], v[204:207], v[68:71]
    v_mfma_f32_16x16x32_bf16 v[72:75], v[188:191], v[208:211], v[72:75]
    v_mfma_f32_16x16x32_bf16 v[76:79], v[188:191], v[212:215], v[76:79]
    v_mfma_f32_16x16x32_bf16 v[80:83], v[192:195], v[200:203], v[80:83]
    v_mfma_f32_16x16x32_bf16 v[84:87], v[192:195], v[204:207], v[84:87]
    v_mfma_f32_16x16x32_bf16 v[88:91], v[192:195], v[208:211], v[88:91]
    v_mfma_f32_16x16x32_bf16 v[92:95], v[192:195], v[212:215], v[92:95]
    v_mfma_f32_16x16x32_bf16 v[96:99], v[196:199], v[200:203], v[96:99]
    v_mfma_f32_16x16x32_bf16 v[100:103], v[196:199], v[204:207], v[100:103]
    v_mfma_f32_16x16x32_bf16 v[104:107], v[196:199], v[208:211], v[104:107]
    v_mfma_f32_16x16x32_bf16 v[108:111], v[196:199], v[212:215], v[108:111]
    s_cmp_eq_u32 s54, 2
    s_cbranch_scc1 K2_W2TAIL
    s_add_u32 s68, s68, 0x400
    s_sub_u32 s69, s68, 57344
    s_cmp_ge_u32 s68, 57344
    s_cselect_b32 s68, s69, s68
    buffer_load_dwordx4 v[184:187], v22, s[36:39], s68 offen offset:0
    buffer_load_dwordx4 v[200:203], v26, s[36:39], s68 offen offset:0
    buffer_load_dwordx4 v[188:191], v23, s[36:39], s68 offen offset:0
    buffer_load_dwordx4 v[204:207], v27, s[36:39], s68 offen offset:0
    buffer_load_dwordx4 v[192:195], v24, s[36:39], s68 offen offset:0
    buffer_load_dwordx4 v[208:211], v28, s[36:39], s68 offen offset:0
    buffer_load_dwordx4 v[196:199], v25, s[36:39], s68 offen offset:0
    buffer_load_dwordx4 v[212:215], v29, s[36:39], s68 offen offset:0
    s_waitcnt vmcnt(56)
    v_mfma_f32_16x16x32_bf16 v[48:51], v[216:219], v[232:235], v[48:51]
    v_mfma_f32_16x16x32_bf16 v[52:55], v[216:219], v[236:239], v[52:55]
    v_mfma_f32_16x16x32_bf16 v[56:59], v[216:219], v[240:243], v[56:59]
    v_mfma_f32_16x16x32_bf16 v[60:63], v[216:219], v[244:247], v[60:63]
    v_mfma_f32_16x16x32_bf16 v[64:67], v[220:223], v[232:235], v[64:67]
    v_mfma_f32_16x16x32_bf16 v[68:71], v[220:223], v[236:239], v[68:71]
    v_mfma_f32_16x16x32_bf16 v[72:75], v[220:223], v[240:243], v[72:75]
    v_mfma_f32_16x16x32_bf16 v[76:79], v[220:223], v[244:247], v[76:79]
    v_mfma_f32_16x16x32_bf16 v[80:83], v[224:227], v[232:235], v[80:83]
    v_mfma_f32_16x16x32_bf16 v[84:87], v[224:227], v[236:239], v[84:87]
    v_mfma_f32_16x16x32_bf16 v[88:91], v[224:227], v[240:243], v[88:91]
    v_mfma_f32_16x16x32_bf16 v[92:95], v[224:227], v[244:247], v[92:95]
    v_mfma_f32_16x16x32_bf16 v[96:99], v[228:231], v[232:235], v[96:99]
    v_mfma_f32_16x16x32_bf16 v[100:103], v[228:231], v[236:239], v[100:103]
    v_mfma_f32_16x16x32_bf16 v[104:107], v[228:231], v[240:243], v[104:107]
    v_mfma_f32_16x16x32_bf16 v[108:111], v[228:231], v[244:247], v[108:111]
    s_waitcnt vmcnt(48)
    v_mfma_f32_16x16x32_bf16 v[48:51], a[0:3], a[16:19], v[48:51]
    v_mfma_f32_16x16x32_bf16 v[52:55], a[0:3], a[20:23], v[52:55]
    v_mfma_f32_16x16x32_bf16 v[56:59], a[0:3], a[24:27], v[56:59]
    v_mfma_f32_16x16x32_bf16 v[60:63], a[0:3], a[28:31], v[60:63]
    v_mfma_f32_16x16x32_bf16 v[64:67], a[4:7], a[16:19], v[64:67]
    v_mfma_f32_16x16x32_bf16 v[68:71], a[4:7], a[20:23], v[68:71]
    v_mfma_f32_16x16x32_bf16 v[72:75], a[4:7], a[24:27], v[72:75]
    v_mfma_f32_16x16x32_bf16 v[76:79], a[4:7], a[28:31], v[76:79]
    v_mfma_f32_16x16x32_bf16 v[80:83], a[8:11], a[16:19], v[80:83]
    v_mfma_f32_16x16x32_bf16 v[84:87], a[8:11], a[20:23], v[84:87]
    v_mfma_f32_16x16x32_bf16 v[88:91], a[8:11], a[24:27], v[88:91]
    v_mfma_f32_16x16x32_bf16 v[92:95], a[8:11], a[28:31], v[92:95]
    v_mfma_f32_16x16x32_bf16 v[96:99], a[12:15], a[16:19], v[96:99]
    v_mfma_f32_16x16x32_bf16 v[100:103], a[12:15], a[20:23], v[100:103]
    v_mfma_f32_16x16x32_bf16 v[104:107], a[12:15], a[24:27], v[104:107]
    v_mfma_f32_16x16x32_bf16 v[108:111], a[12:15], a[28:31], v[108:111]
    s_waitcnt vmcnt(40)
    v_mfma_f32_16x16x32_bf16 v[48:51], a[32:35], a[48:51], v[48:51]
    v_mfma_f32_16x16x32_bf16 v[52:55], a[32:35], a[52:55], v[52:55]
    v_mfma_f32_16x16x32_bf16 v[56:59], a[32:35], a[56:59], v[56:59]
    v_mfma_f32_16x16x32_bf16 v[60:63], a[32:35], a[60:63], v[60:63]
    v_mfma_f32_16x16x32_bf16 v[64:67], a[36:39], a[48:51], v[64:67]
    v_mfma_f32_16x16x32_bf16 v[68:71], a[36:39], a[52:55], v[68:71]
    v_mfma_f32_16x16x32_bf16 v[72:75], a[36:39], a[56:59], v[72:75]
    v_mfma_f32_16x16x32_bf16 v[76:79], a[36:39], a[60:63], v[76:79]
    v_mfma_f32_16x16x32_bf16 v[80:83], a[40:43], a[48:51], v[80:83]
    v_mfma_f32_16x16x32_bf16 v[84:87], a[40:43], a[52:55], v[84:87]
    v_mfma_f32_16x16x32_bf16 v[88:91], a[40:43], a[56:59], v[88:91]
    v_mfma_f32_16x16x32_bf16 v[92:95], a[40:43], a[60:63], v[92:95]
    v_mfma_f32_16x16x32_bf16 v[96:99], a[44:47], a[48:51], v[96:99]
    v_mfma_f32_16x16x32_bf16 v[100:103], a[44:47], a[52:55], v[100:103]
    v_mfma_f32_16x16x32_bf16 v[104:107], a[44:47], a[56:59], v[104:107]
    v_mfma_f32_16x16x32_bf16 v[108:111], a[44:47], a[60:63], v[108:111]
    s_waitcnt vmcnt(32)
    v_mfma_f32_16x16x32_bf16 v[48:51], a[64:67], a[80:83], v[48:51]
    v_mfma_f32_16x16x32_bf16 v[52:55], a[64:67], a[84:87], v[52:55]
    v_mfma_f32_16x16x32_bf16 v[56:59], a[64:67], a[88:91], v[56:59]
    v_mfma_f32_16x16x32_bf16 v[60:63], a[64:67], a[92:95], v[60:63]
    v_mfma_f32_16x16x32_bf16 v[64:67], a[68:71], a[80:83], v[64:67]
    v_mfma_f32_16x16x32_bf16 v[68:71], a[68:71], a[84:87], v[68:71]
    v_mfma_f32_16x16x32_bf16 v[72:75], a[68:71], a[88:91], v[72:75]
    v_mfma_f32_16x16x32_bf16 v[76:79], a[68:71], a[92:95], v[76:79]
    v_mfma_f32_16x16x32_bf16 v[80:83], a[72:75], a[80:83], v[80:83]
    v_mfma_f32_16x16x32_bf16 v[84:87], a[72:75], a[84:87], v[84:87]
    v_mfma_f32_16x16x32_bf16 v[88:91], a[72:75], a[88:91], v[88:91]
    v_mfma_f32_16x16x32_bf16 v[92:95], a[72:75], a[92:95], v[92:95]
    v_mfma_f32_16x16x32_bf16 v[96:99], a[76:79], a[80:83], v[96:99]
    v_mfma_f32_16x16x32_bf16 v[100:103], a[76:79], a[84:87], v[100:103]
    v_mfma_f32_16x16x32_bf16 v[104:107], a[76:79], a[88:91], v[104:107]
    v_mfma_f32_16x16x32_bf16 v[108:111], a[76:79], a[92:95], v[108:111]
    s_waitcnt vmcnt(24)
    v_mfma_f32_16x16x32_bf16 v[48:51], a[96:99], a[112:115], v[48:51]
    v_mfma_f32_16x16x32_bf16 v[52:55], a[96:99], a[116:119], v[52:55]
    v_mfma_f32_16x16x32_bf16 v[56:59], a[96:99], a[120:123], v[56:59]
    v_mfma_f32_16x16x32_bf16 v[60:63], a[96:99], a[124:127], v[60:63]
    v_mfma_f32_16x16x32_bf16 v[64:67], a[100:103], a[112:115], v[64:67]
    v_mfma_f32_16x16x32_bf16 v[68:71], a[100:103], a[116:119], v[68:71]
    v_mfma_f32_16x16x32_bf16 v[72:75], a[100:103], a[120:123], v[72:75]
    v_mfma_f32_16x16x32_bf16 v[76:79], a[100:103], a[124:127], v[76:79]
    v_mfma_f32_16x16x32_bf16 v[80:83], a[104:107], a[112:115], v[80:83]
    v_mfma_f32_16x16x32_bf16 v[84:87], a[104:107], a[116:119], v[84:87]
    v_mfma_f32_16x16x32_bf16 v[88:91], a[104:107], a[120:123], v[88:91]
    v_mfma_f32_16x16x32_bf16 v[92:95], a[104:107], a[124:127], v[92:95]
    v_mfma_f32_16x16x32_bf16 v[96:99], a[108:111], a[112:115], v[96:99]
    v_mfma_f32_16x16x32_bf16 v[100:103], a[108:111], a[116:119], v[100:103]
    v_mfma_f32_16x16x32_bf16 v[104:107], a[108:111], a[120:123], v[104:107]
    v_mfma_f32_16x16x32_bf16 v[108:111], a[108:111], a[124:127], v[108:111]
    s_waitcnt vmcnt(16)
    v_mfma_f32_16x16x32_bf16 v[48:51], v[120:123], v[136:139], v[48:51]
    v_mfma_f32_16x16x32_bf16 v[52:55], v[120:123], v[140:143], v[52:55]
    v_mfma_f32_16x16x32_bf16 v[56:59], v[120:123], v[144:147], v[56:59]
    v_mfma_f32_16x16x32_bf16 v[60:63], v[120:123], v[148:151], v[60:63]
    v_mfma_f32_16x16x32_bf16 v[64:67], v[124:127], v[136:139], v[64:67]
    v_mfma_f32_16x16x32_bf16 v[68:71], v[124:127], v[140:143], v[68:71]
    v_mfma_f32_16x16x32_bf16 v[72:75], v[124:127], v[144:147], v[72:75]
    v_mfma_f32_16x16x32_bf16 v[76:79], v[124:127], v[148:151], v[76:79]
    v_mfma_f32_16x16x32_bf16 v[80:83], v[128:131], v[136:139], v[80:83]
    v_mfma_f32_16x16x32_bf16 v[84:87], v[128:131], v[140:143], v[84:87]
    v_mfma_f32_16x16x32_bf16 v[88:91], v[128:131], v[144:147], v[88:91]
    v_mfma_f32_16x16x32_bf16 v[92:95], v[128:131], v[148:151], v[92:95]
    v_mfma_f32_16x16x32_bf16 v[96:99], v[132:135], v[136:139], v[96:99]
    v_mfma_f32_16x16x32_bf16 v[100:103], v[132:135], v[140:143], v[100:103]
    v_mfma_f32_16x16x32_bf16 v[104:107], v[132:135], v[144:147], v[104:107]
    v_mfma_f32_16x16x32_bf16 v[108:111], v[132:135], v[148:151], v[108:111]
    s_waitcnt vmcnt(8)
    v_mfma_f32_16x16x32_bf16 v[48:51], v[152:155], v[168:171], v[48:51]
    v_mfma_f32_16x16x32_bf16 v[52:55], v[152:155], v[172:175], v[52:55]
    v_mfma_f32_16x16x32_bf16 v[56:59], v[152:155], v[176:179], v[56:59]
    v_mfma_f32_16x16x32_bf16 v[60:63], v[152:155], v[180:183], v[60:63]
    v_mfma_f32_16x16x32_bf16 v[64:67], v[156:159], v[168:171], v[64:67]
    v_mfma_f32_16x16x32_bf16 v[68:71], v[156:159], v[172:175], v[68:71]
    v_mfma_f32_16x16x32_bf16 v[72:75], v[156:159], v[176:179], v[72:75]
    v_mfma_f32_16x16x32_bf16 v[76:79], v[156:159], v[180:183], v[76:79]
    v_mfma_f32_16x16x32_bf16 v[80:83], v[160:163], v[168:171], v[80:83]
    v_mfma_f32_16x16x32_bf16 v[84:87], v[160:163], v[172:175], v[84:87]
    v_mfma_f32_16x16x32_bf16 v[88:91], v[160:163], v[176:179], v[88:91]
    v_mfma_f32_16x16x32_bf16 v[92:95], v[160:163], v[180:183], v[92:95]
    v_mfma_f32_16x16x32_bf16 v[96:99], v[164:167], v[168:171], v[96:99]
    v_mfma_f32_16x16x32_bf16 v[100:103], v[164:167], v[172:175], v[100:103]
    v_mfma_f32_16x16x32_bf16 v[104:107], v[164:167], v[176:179], v[104:107]
    v_mfma_f32_16x16x32_bf16 v[108:111], v[164:167], v[180:183], v[108:111]
    s_waitcnt vmcnt(0)
    v_mfma_f32_16x16x32_bf16 v[48:51], v[184:187], v[200:203], v[48:51]
    v_mfma_f32_16x16x32_bf16 v[52:55], v[184:187], v[204:207], v[52:55]
    v_mfma_f32_16x16x32_bf16 v[56:59], v[184:187], v[208:211], v[56:59]
    v_mfma_f32_16x16x32_bf16 v[60:63], v[184:187], v[212:215], v[60:63]
    v_mfma_f32_16x16x32_bf16 v[64:67], v[188:191], v[200:203], v[64:67]
    v_mfma_f32_16x16x32_bf16 v[68:71], v[188:191], v[204:207], v[68:71]
    v_mfma_f32_16x16x32_bf16 v[72:75], v[188:191], v[208:211], v[72:75]
    v_mfma_f32_16x16x32_bf16 v[76:79], v[188:191], v[212:215], v[76:79]
    v_mfma_f32_16x16x32_bf16 v[80:83], v[192:195], v[200:203], v[80:83]
    v_mfma_f32_16x16x32_bf16 v[84:87], v[192:195], v[204:207], v[84:87]
    v_mfma_f32_16x16x32_bf16 v[88:91], v[192:195], v[208:211], v[88:91]
    v_mfma_f32_16x16x32_bf16 v[92:95], v[192:195], v[212:215], v[92:95]
    v_mfma_f32_16x16x32_bf16 v[96:99], v[196:199], v[200:203], v[96:99]
    v_mfma_f32_16x16x32_bf16 v[100:103], v[196:199], v[204:207], v[100:103]
    v_mfma_f32_16x16x32_bf16 v[104:107], v[196:199], v[208:211], v[104:107]
    v_mfma_f32_16x16x32_bf16 v[108:111], v[196:199], v[212:215], v[108:111]
    s_branch K2_FFN_DONE
K2_W2TAIL:
    s_waitcnt vmcnt(48)
    v_mfma_f32_16x16x32_bf16 v[48:51], v[216:219], v[232:235], v[48:51]
    v_mfma_f32_16x16x32_bf16 v[52:55], v[216:219], v[236:239], v[52:55]
    v_mfma_f32_16x16x32_bf16 v[56:59], v[216:219], v[240:243], v[56:59]
    v_mfma_f32_16x16x32_bf16 v[60:63], v[216:219], v[244:247], v[60:63]
    v_mfma_f32_16x16x32_bf16 v[64:67], v[220:223], v[232:235], v[64:67]
    v_mfma_f32_16x16x32_bf16 v[68:71], v[220:223], v[236:239], v[68:71]
    v_mfma_f32_16x16x32_bf16 v[72:75], v[220:223], v[240:243], v[72:75]
    v_mfma_f32_16x16x32_bf16 v[76:79], v[220:223], v[244:247], v[76:79]
    v_mfma_f32_16x16x32_bf16 v[80:83], v[224:227], v[232:235], v[80:83]
    v_mfma_f32_16x16x32_bf16 v[84:87], v[224:227], v[236:239], v[84:87]
    v_mfma_f32_16x16x32_bf16 v[88:91], v[224:227], v[240:243], v[88:91]
    v_mfma_f32_16x16x32_bf16 v[92:95], v[224:227], v[244:247], v[92:95]
    v_mfma_f32_16x16x32_bf16 v[96:99], v[228:231], v[232:235], v[96:99]
    v_mfma_f32_16x16x32_bf16 v[100:103], v[228:231], v[236:239], v[100:103]
    v_mfma_f32_16x16x32_bf16 v[104:107], v[228:231], v[240:243], v[104:107]
    v_mfma_f32_16x16x32_bf16 v[108:111], v[228:231], v[244:247], v[108:111]
    s_waitcnt vmcnt(40)
    v_mfma_f32_16x16x32_bf16 v[48:51], a[0:3], a[16:19], v[48:51]
    v_mfma_f32_16x16x32_bf16 v[52:55], a[0:3], a[20:23], v[52:55]
    v_mfma_f32_16x16x32_bf16 v[56:59], a[0:3], a[24:27], v[56:59]
    v_mfma_f32_16x16x32_bf16 v[60:63], a[0:3], a[28:31], v[60:63]
    v_mfma_f32_16x16x32_bf16 v[64:67], a[4:7], a[16:19], v[64:67]
    v_mfma_f32_16x16x32_bf16 v[68:71], a[4:7], a[20:23], v[68:71]
    v_mfma_f32_16x16x32_bf16 v[72:75], a[4:7], a[24:27], v[72:75]
    v_mfma_f32_16x16x32_bf16 v[76:79], a[4:7], a[28:31], v[76:79]
    v_mfma_f32_16x16x32_bf16 v[80:83], a[8:11], a[16:19], v[80:83]
    v_mfma_f32_16x16x32_bf16 v[84:87], a[8:11], a[20:23], v[84:87]
    v_mfma_f32_16x16x32_bf16 v[88:91], a[8:11], a[24:27], v[88:91]
    v_mfma_f32_16x16x32_bf16 v[92:95], a[8:11], a[28:31], v[92:95]
    v_mfma_f32_16x16x32_bf16 v[96:99], a[12:15], a[16:19], v[96:99]
    v_mfma_f32_16x16x32_bf16 v[100:103], a[12:15], a[20:23], v[100:103]
    v_mfma_f32_16x16x32_bf16 v[104:107], a[12:15], a[24:27], v[104:107]
    v_mfma_f32_16x16x32_bf16 v[108:111], a[12:15], a[28:31], v[108:111]
    s_waitcnt vmcnt(32)
    v_mfma_f32_16x16x32_bf16 v[48:51], a[32:35], a[48:51], v[48:51]
    v_mfma_f32_16x16x32_bf16 v[52:55], a[32:35], a[52:55], v[52:55]
    v_mfma_f32_16x16x32_bf16 v[56:59], a[32:35], a[56:59], v[56:59]
    v_mfma_f32_16x16x32_bf16 v[60:63], a[32:35], a[60:63], v[60:63]
    v_mfma_f32_16x16x32_bf16 v[64:67], a[36:39], a[48:51], v[64:67]
    v_mfma_f32_16x16x32_bf16 v[68:71], a[36:39], a[52:55], v[68:71]
    v_mfma_f32_16x16x32_bf16 v[72:75], a[36:39], a[56:59], v[72:75]
    v_mfma_f32_16x16x32_bf16 v[76:79], a[36:39], a[60:63], v[76:79]
    v_mfma_f32_16x16x32_bf16 v[80:83], a[40:43], a[48:51], v[80:83]
    v_mfma_f32_16x16x32_bf16 v[84:87], a[40:43], a[52:55], v[84:87]
    v_mfma_f32_16x16x32_bf16 v[88:91], a[40:43], a[56:59], v[88:91]
    v_mfma_f32_16x16x32_bf16 v[92:95], a[40:43], a[60:63], v[92:95]
    v_mfma_f32_16x16x32_bf16 v[96:99], a[44:47], a[48:51], v[96:99]
    v_mfma_f32_16x16x32_bf16 v[100:103], a[44:47], a[52:55], v[100:103]
    v_mfma_f32_16x16x32_bf16 v[104:107], a[44:47], a[56:59], v[104:107]
    v_mfma_f32_16x16x32_bf16 v[108:111], a[44:47], a[60:63], v[108:111]
    s_waitcnt vmcnt(24)
    v_mfma_f32_16x16x32_bf16 v[48:51], a[64:67], a[80:83], v[48:51]
    v_mfma_f32_16x16x32_bf16 v[52:55], a[64:67], a[84:87], v[52:55]
    v_mfma_f32_16x16x32_bf16 v[56:59], a[64:67], a[88:91], v[56:59]
    v_mfma_f32_16x16x32_bf16 v[60:63], a[64:67], a[92:95], v[60:63]
    v_mfma_f32_16x16x32_bf16 v[64:67], a[68:71], a[80:83], v[64:67]
    v_mfma_f32_16x16x32_bf16 v[68:71], a[68:71], a[84:87], v[68:71]
    v_mfma_f32_16x16x32_bf16 v[72:75], a[68:71], a[88:91], v[72:75]
    v_mfma_f32_16x16x32_bf16 v[76:79], a[68:71], a[92:95], v[76:79]
    v_mfma_f32_16x16x32_bf16 v[80:83], a[72:75], a[80:83], v[80:83]
    v_mfma_f32_16x16x32_bf16 v[84:87], a[72:75], a[84:87], v[84:87]
    v_mfma_f32_16x16x32_bf16 v[88:91], a[72:75], a[88:91], v[88:91]
    v_mfma_f32_16x16x32_bf16 v[92:95], a[72:75], a[92:95], v[92:95]
    v_mfma_f32_16x16x32_bf16 v[96:99], a[76:79], a[80:83], v[96:99]
    v_mfma_f32_16x16x32_bf16 v[100:103], a[76:79], a[84:87], v[100:103]
    v_mfma_f32_16x16x32_bf16 v[104:107], a[76:79], a[88:91], v[104:107]
    v_mfma_f32_16x16x32_bf16 v[108:111], a[76:79], a[92:95], v[108:111]
    s_waitcnt vmcnt(16)
    v_mfma_f32_16x16x32_bf16 v[48:51], a[96:99], a[112:115], v[48:51]
    v_mfma_f32_16x16x32_bf16 v[52:55], a[96:99], a[116:119], v[52:55]
    v_mfma_f32_16x16x32_bf16 v[56:59], a[96:99], a[120:123], v[56:59]
    v_mfma_f32_16x16x32_bf16 v[60:63], a[96:99], a[124:127], v[60:63]
    v_mfma_f32_16x16x32_bf16 v[64:67], a[100:103], a[112:115], v[64:67]
    v_mfma_f32_16x16x32_bf16 v[68:71], a[100:103], a[116:119], v[68:71]
    v_mfma_f32_16x16x32_bf16 v[72:75], a[100:103], a[120:123], v[72:75]
    v_mfma_f32_16x16x32_bf16 v[76:79], a[100:103], a[124:127], v[76:79]
    v_mfma_f32_16x16x32_bf16 v[80:83], a[104:107], a[112:115], v[80:83]
    v_mfma_f32_16x16x32_bf16 v[84:87], a[104:107], a[116:119], v[84:87]
    v_mfma_f32_16x16x32_bf16 v[88:91], a[104:107], a[120:123], v[88:91]
    v_mfma_f32_16x16x32_bf16 v[92:95], a[104:107], a[124:127], v[92:95]
    v_mfma_f32_16x16x32_bf16 v[96:99], a[108:111], a[112:115], v[96:99]
    v_mfma_f32_16x16x32_bf16 v[100:103], a[108:111], a[116:119], v[100:103]
    v_mfma_f32_16x16x32_bf16 v[104:107], a[108:111], a[120:123], v[104:107]
    v_mfma_f32_16x16x32_bf16 v[108:111], a[108:111], a[124:127], v[108:111]
    s_waitcnt vmcnt(8)
    v_mfma_f32_16x16x32_bf16 v[48:51], v[120:123], v[136:139], v[48:51]
    v_mfma_f32_16x16x32_bf16 v[52:55], v[120:123], v[140:143], v[52:55]
    v_mfma_f32_16x16x32_bf16 v[56:59], v[120:123], v[144:147], v[56:59]
    v_mfma_f32_16x16x32_bf16 v[60:63], v[120:123], v[148:151], v[60:63]
    v_mfma_f32_16x16x32_bf16 v[64:67], v[124:127], v[136:139], v[64:67]
    v_mfma_f32_16x16x32_bf16 v[68:71], v[124:127], v[140:143], v[68:71]
    v_mfma_f32_16x16x32_bf16 v[72:75], v[124:127], v[144:147], v[72:75]
    v_mfma_f32_16x16x32_bf16 v[76:79], v[124:127], v[148:151], v[76:79]
    v_mfma_f32_16x16x32_bf16 v[80:83], v[128:131], v[136:139], v[80:83]
    v_mfma_f32_16x16x32_bf16 v[84:87], v[128:131], v[140:143], v[84:87]
    v_mfma_f32_16x16x32_bf16 v[88:91], v[128:131], v[144:147], v[88:91]
    v_mfma_f32_16x16x32_bf16 v[92:95], v[128:131], v[148:151], v[92:95]
    v_mfma_f32_16x16x32_bf16 v[96:99], v[132:135], v[136:139], v[96:99]
    v_mfma_f32_16x16x32_bf16 v[100:103], v[132:135], v[140:143], v[100:103]
    v_mfma_f32_16x16x32_bf16 v[104:107], v[132:135], v[144:147], v[104:107]
    v_mfma_f32_16x16x32_bf16 v[108:111], v[132:135], v[148:151], v[108:111]
    s_waitcnt vmcnt(0)
    v_mfma_f32_16x16x32_bf16 v[48:51], v[152:155], v[168:171], v[48:51]
    v_mfma_f32_16x16x32_bf16 v[52:55], v[152:155], v[172:175], v[52:55]
    v_mfma_f32_16x16x32_bf16 v[56:59], v[152:155], v[176:179], v[56:59]
    v_mfma_f32_16x16x32_bf16 v[60:63], v[152:155], v[180:183], v[60:63]
    v_mfma_f32_16x16x32_bf16 v[64:67], v[156:159], v[168:171], v[64:67]
    v_mfma_f32_16x16x32_bf16 v[68:71], v[156:159], v[172:175], v[68:71]
    v_mfma_f32_16x16x32_bf16 v[72:75], v[156:159], v[176:179], v[72:75]
    v_mfma_f32_16x16x32_bf16 v[76:79], v[156:159], v[180:183], v[76:79]
    v_mfma_f32_16x16x32_bf16 v[80:83], v[160:163], v[168:171], v[80:83]
    v_mfma_f32_16x16x32_bf16 v[84:87], v[160:163], v[172:175], v[84:87]
    v_mfma_f32_16x16x32_bf16 v[88:91], v[160:163], v[176:179], v[88:91]
    v_mfma_f32_16x16x32_bf16 v[92:95], v[160:163], v[180:183], v[92:95]
    v_mfma_f32_16x16x32_bf16 v[96:99], v[164:167], v[168:171], v[96:99]
    v_mfma_f32_16x16x32_bf16 v[100:103], v[164:167], v[172:175], v[100:103]
    v_mfma_f32_16x16x32_bf16 v[104:107], v[164:167], v[176:179], v[104:107]
    v_mfma_f32_16x16x32_bf16 v[108:111], v[164:167], v[180:183], v[108:111]
K2_FFN_DONE:
    s_mul_i32 s66, s54, 17408
    v_mul_u32_u24 v30, 272, v2
    v_lshl_add_u32 v30, v3, 4, v30
    v_add_u32 v30, s66, v30
    s_nop 5
    ds_write_b128 v30, v[48:51] offset:0
    ds_write_b128 v30, v[52:55] offset:4352
    ds_write_b128 v30, v[56:59] offset:8704
    ds_write_b128 v30, v[60:63] offset:13056
    ds_write_b128 v30, v[64:67] offset:64
    ds_write_b128 v30, v[68:71] offset:4416
    ds_write_b128 v30, v[72:75] offset:8768
    ds_write_b128 v30, v[76:79] offset:13120
    ds_write_b128 v30, v[80:83] offset:128
    ds_write_b128 v30, v[84:87] offset:4480
    ds_write_b128 v30, v[88:91] offset:8832
    ds_write_b128 v30, v[92:95] offset:13184
    ds_write_b128 v30, v[96:99] offset:192
    ds_write_b128 v30, v[100:103] offset:4544
    ds_write_b128 v30, v[104:107] offset:8896
    ds_write_b128 v30, v[108:111] offset:13248
    s_branch K2_FINAL
K2_DFT:
    s_mul_i32 s68, s56, 0x44000
    s_lshl_b32 s69, s53, 15
    s_add_u32 s68, s68, s69
    s_add_u32 s68, s68, 0xa00000
    s_add_u32 s69, s68, 0x88000
    v_add_u32 v23, 0x4000, v4
    v_lshlrev_b32 v24, 8, v3
    v_add_u32 v24, 0x8000, v24
    buffer_load_dwordx4 a[0:3], v4, s[36:39], s68 offen offset:0
    buffer_load_dwordx4 a[12:15], v4, s[36:39], s69 offen offset:0
    buffer_load_dwordx4 a[4:7], v23, s[36:39], s68 offen offset:0
    buffer_load_dwordx4 a[16:19], v23, s[36:39], s69 offen offset:0
    buffer_load_dwordx4 a[8:11], v24, s[36:39], s68 offen offset:0
    buffer_load_dwordx4 a[20:23], v24, s[36:39], s69 offen offset:0
    buffer_load_dwordx4 a[24:27], v4, s[36:39], s68 offen offset:1024
    buffer_load_dwordx4 a[36:39], v4, s[36:39], s69 offen offset:1024
    buffer_load_dwordx4 a[28:31], v23, s[36:39], s68 offen offset:1024
    buffer_load_dwordx4 a[40:43], v23, s[36:39], s69 offen offset:1024
    buffer_load_dwordx4 a[32:35], v24, s[36:39], s68 offen offset:1024
    buffer_load_dwordx4 a[44:47], v24, s[36:39], s69 offen offset:1024
    s_lshl_b32 s70, s53, 7
    s_add_u32 s70, s70, 0xb10000
    v_lshlrev_b32 v37, 4, v3
    buffer_load_dwordx4 v[120:123], v37, s[36:39], s70 offen offset:0
    buffer_load_dwordx4 v[132:135], v37, s[36:39], s70 offen offset:1152
    buffer_load_dwordx4 v[124:127], v37, s[36:39], s70 offen offset:64
    buffer_load_dwordx4 v[136:139], v37, s[36:39], s70 offen offset:1216
    buffer_load_dwordx4 v[128:131], v37, s[36:39], s70 offen offset:128
    buffer_load_dwordx4 v[140:143], v37, s[36:39], s70 offen offset:1280
    s_mov_b32 s32, s4
    s_and_b32 s33, s5, 0xffff
    s_mov_b32 s34, 0x200000
    s_mov_b32 s35, 0x00020000
    s_mov_b32 s40, s22
    s_and_b32 s41, s23, 0xffff
    s_mov_b32 s42, 0x400
    s_mov_b32 s43, 0x00020000
    s_mov_b32 s60, s24
    s_and_b32 s61, s25, 0xffff
    s_mov_b32 s62, 0x200000
    s_mov_b32 s63, 0x00020000
    v_bfe_u32 v30, v1, 2, 2
    v_mov_b32 v31, 0x400
    v_cmp_eq_u32 vcc, 0, v30
    v_add_u32 v34, 1, v30
    v_and_b32 v34, 2, v34
    v_cndmask_b32 v31, v31, 0, vcc
    v_sub_u32 v32, 1, v34
    v_cmp_eq_u32 vcc, 1, v30
    v_mov_b32 v34, 0x800
    v_and_b32 v33, 1, v30
    v_cndmask_b32 v31, v31, v34, vcc
    v_lshlrev_b32 v33, 10, v33
    v_lshrrev_b32 v34, 1, v30
    v_lshl_add_u32 v33, v34, 9, v33
    s_lshl_b32 s66, s54, 3
    s_add_u32 s66, s66, s57
    v_lshl_add_u32 v34, v3, 1, s66
    v_mad_i32_i24 v35, v32, v34, v31
    v_cmp_eq_u32 vcc, 0, v34
    v_and_b32 v36, 3, v1
    v_lshlrev_b32 v36, 4, v36
    v_cndmask_b32 v35, v35, v33, vcc
    v_lshl_add_u32 v5, v35, 10, v36
    s_lshl_b32 s64, s53, 6
    s_sub_u32 s65, 960, s64
    buffer_load_dwordx4 v[6:9], v5, s[32:35], s64 offen
    buffer_load_dwordx4 v[10:13], v5, s[32:35], s65 offen
    buffer_load_dwordx4 v[14:17], v36, s[40:43], s64 offen
    buffer_load_dwordx4 v[18:21], v36, s[40:43], s65 offen
    buffer_load_dwordx4 a[48:51], v4, s[36:39], s68 offen offset:2048
    buffer_load_dwordx4 a[60:63], v4, s[36:39], s69 offen offset:2048
    buffer_load_dwordx4 a[52:55], v23, s[36:39], s68 offen offset:2048
    buffer_load_dwordx4 a[64:67], v23, s[36:39], s69 offen offset:2048
    buffer_load_dwordx4 a[56:59], v24, s[36:39], s68 offen offset:2048
    buffer_load_dwordx4 a[68:71], v24, s[36:39], s69 offen offset:2048
    buffer_load_dwordx4 a[72:75], v4, s[36:39], s68 offen offset:3072
    buffer_load_dwordx4 a[84:87], v4, s[36:39], s69 offen offset:3072
    buffer_load_dwordx4 a[76:79], v23, s[36:39], s68 offen offset:3072
    buffer_load_dwordx4 a[88:91], v23, s[36:39], s69 offen offset:3072
    buffer_load_dwordx4 a[80:83], v24, s[36:39], s68 offen offset:3072
    buffer_load_dwordx4 a[92:95], v24, s[36:39], s69 offen offset:3072
    s_add_u32 s68, s68, 0x1000
    s_add_u32 s69, s69, 0x1000
    buffer_load_dwordx4 a[96:99], v4, s[36:39], s68 offen offset:0
    buffer_load_dwordx4 a[108:111], v4, s[36:39], s69 offen offset:0
    buffer_load_dwordx4 a[100:103], v23, s[36:39], s68 offen offset:0
    buffer_load_dwordx4 a[112:115], v23, s[36:39], s69 offen offset:0
    buffer_load_dwordx4 a[104:107], v24, s[36:39], s68 offen offset:0
    buffer_load_dwordx4 a[116:119], v24, s[36:39], s69 offen offset:0
    buffer_load_dwordx4 a[120:123], v4, s[36:39], s68 offen offset:1024
    buffer_load_dwordx4 a[132:135], v4, s[36:39], s69 offen offset:1024
    buffer_load_dwordx4 a[124:127], v23, s[36:39], s68 offen offset:1024
    buffer_load_dwordx4 a[136:139], v23, s[36:39], s69 offen offset:1024
    buffer_load_dwordx4 a[128:131], v24, s[36:39], s68 offen offset:1024
    buffer_load_dwordx4 a[140:143], v24, s[36:39], s69 offen offset:1024
    buffer_load_dwordx4 a[144:147], v4, s[36:39], s68 offen offset:2048
    buffer_load_dwordx4 a[156:159], v4, s[36:39], s69 offen offset:2048
    buffer_load_dwordx4 a[148:151], v23, s[36:39], s68 offen offset:2048
    buffer_load_dwordx4 a[160:163], v23, s[36:39], s69 offen offset:2048
    buffer_load_dwordx4 a[152:155], v24, s[36:39], s68 offen offset:2048
    buffer_load_dwordx4 a[164:167], v24, s[36:39], s69 offen offset:2048
    v_lshl_add_u32 v40, v2, 1, s57
    v_cvt_f32_u32 v40, v40
    v_mul_f32 v41, 0x3d000000, v40
    v_mul_f32 v42, 0x3a000000, v40
    v_mul_f32 v43, 0x3e800000, v40
    v_sin_f32 v44, -v43
    v_cos_f32 v43, v43
    v_lshlrev_b32 v38, 4, v3
    v_mov_b32 v144, 0x3f803f80
    v_mov_b32 v145, 0xbf80bf80
    v_mov_b32 v146, 0x3f803f80
    v_mov_b32 v147, 0xbf80bf80
    v_add_u32 v39, 0, v38
    v_cvt_f32_u32 v39, v39
    v_mul_f32 v148, v39, v42
    v_add_u32 v39, 8, v38
    v_cvt_f32_u32 v39, v39
    v_mul_f32 v149, v39, v42
    v_add_u32 v39, 2, v38
    v_cvt_f32_u32 v39, v39
    v_mul_f32 v150, v39, v42
    v_add_u32 v39, 10, v38
    v_cvt_f32_u32 v39, v39
    v_mul_f32 v151, v39, v42
    v_add_u32 v39, 4, v38
    v_cvt_f32_u32 v39, v39
    v_mul_f32 v152, v39, v42
    v_add_u32 v39, 12, v38
    v_cvt_f32_u32 v39, v39
    v_mul_f32 v153, v39, v42
    v_add_u32 v39, 6, v38
    v_cvt_f32_u32 v39, v39
    v_mul_f32 v154, v39, v42
    v_add_u32 v39, 14, v38
    v_cvt_f32_u32 v39, v39
    v_mul_f32 v155, v39, v42
    v_cos_f32 v156, v148
    v_sin_f32 v164, -v148
    v_cos_f32 v157, v149
    v_sin_f32 v165, -v149
    v_cos_f32 v158, v150
    v_sin_f32 v166, -v150
    v_cos_f32 v159, v151
    v_sin_f32 v167, -v151
    v_cos_f32 v160, v152
    v_sin_f32 v168, -v152
    v_cos_f32 v161, v153
    v_sin_f32 v169, -v153
    v_cos_f32 v162, v154
    v_sin_f32 v170, -v154
    v_cos_f32 v163, v155
    v_sin_f32 v171, -v155
    s_nop 0
    v_cvt_pk_bf16_f32 v172, v156, v157
    v_cvt_pk_bf16_f32 v173, v158, v159
    v_cvt_pk_bf16_f32 v174, v160, v161
    v_cvt_pk_bf16_f32 v175, v162, v163
    v_cvt_pk_bf16_f32 v176, v164, v165
    v_cvt_pk_bf16_f32 v177, v166, v167
    v_cvt_pk_bf16_f32 v178, v168, v169
    v_cvt_pk_bf16_f32 v179, v170, v171
    buffer_load_dwordx4 a[168:171], v4, s[36:39], s68 offen offset:3072
    buffer_load_dwordx4 a[180:183], v4, s[36:39], s69 offen offset:3072
    buffer_load_dwordx4 a[172:175], v23, s[36:39], s68 offen offset:3072
    buffer_load_dwordx4 a[184:187], v23, s[36:39], s69 offen offset:3072
    buffer_load_dwordx4 a[176:179], v24, s[36:39], s68 offen offset:3072
    buffer_load_dwordx4 a[188:191], v24, s[36:39], s69 offen offset:3072
    v_add_f32 v148, v148, v41
    v_add_f32 v149, v149, v41
    v_add_f32 v150, v150, v41
    v_add_f32 v151, v151, v41
    v_add_f32 v152, v152, v41
    v_add_f32 v153, v153, v41
    v_add_f32 v154, v154, v41
    v_add_f32 v155, v155, v41
    v_cos_f32 v156, v148
    v_sin_f32 v164, -v148
    v_cos_f32 v157, v149
    v_sin_f32 v165, -v149
    v_cos_f32 v158, v150
    v_sin_f32 v166, -v150
    v_cos_f32 v159, v151
    v_sin_f32 v167, -v151
    v_cos_f32 v160, v152
    v_sin_f32 v168, -v152
    v_cos_f32 v161, v153
    v_sin_f32 v169, -v153
    v_cos_f32 v162, v154
    v_sin_f32 v170, -v154
    v_cos_f32 v163, v155
    v_sin_f32 v171, -v155
    s_nop 0
    v_cvt_pk_bf16_f32 v180, v156, v157
    v_cvt_pk_bf16_f32 v181, v158, v159
    v_cvt_pk_bf16_f32 v182, v160, v161
    v_cvt_pk_bf16_f32 v183, v162, v163
    v_cvt_pk_bf16_f32 v184, v164, v165
    v_cvt_pk_bf16_f32 v185, v166, v167
    v_cvt_pk_bf16_f32 v186, v168, v169
    v_cvt_pk_bf16_f32 v187, v170, v171
    s_waitcnt vmcnt(52)
    v_mfma_f32_16x16x32_bf16 v[48:51], a[0:3], v[172:175], 0
    v_mfma_f32_16x16x32_bf16 v[52:55], a[4:7], v[172:175], 0
    v_mfma_f32_16x16x32_bf16 v[56:59], a[8:11], v[172:175], 0
    v_mfma_f32_16x16x32_bf16 v[72:75], a[12:15], v[176:179], 0
    v_mfma_f32_16x16x32_bf16 v[76:79], a[16:19], v[176:179], 0
    v_mfma_f32_16x16x32_bf16 v[80:83], a[20:23], v[176:179], 0
    v_mfma_f32_16x16x32_bf16 v[96:99], a[0:3], v[144:147], 0
    v_mfma_f32_16x16x32_bf16 v[100:103], a[4:7], v[144:147], 0
    v_mfma_f32_16x16x32_bf16 v[104:107], a[8:11], v[144:147], 0
    s_add_u32 s68, s68, 0x1000
    s_add_u32 s69, s69, 0x1000
    buffer_load_dwordx4 a[0:3], v4, s[36:39], s68 offen offset:0
    buffer_load_dwordx4 a[12:15], v4, s[36:39], s69 offen offset:0
    buffer_load_dwordx4 a[4:7], v23, s[36:39], s68 offen offset:0
    buffer_load_dwordx4 a[16:19], v23, s[36:39], s69 offen offset:0
    buffer_load_dwordx4 a[8:11], v24, s[36:39], s68 offen offset:0
    buffer_load_dwordx4 a[20:23], v24, s[36:39], s69 offen offset:0
    v_add_f32 v148, v148, v41
    v_add_f32 v149, v149, v41
    v_add_f32 v150, v150, v41
    v_add_f32 v151, v151, v41
    v_add_f32 v152, v152, v41
    v_add_f32 v153, v153, v41
    v_add_f32 v154, v154, v41
    v_add_f32 v155, v155, v41
    v_cos_f32 v156, v148
    v_sin_f32 v164, -v148
    v_cos_f32 v157, v149
    v_sin_f32 v165, -v149
    v_cos_f32 v158, v150
    v_sin_f32 v166, -v150
    v_cos_f32 v159, v151
    v_sin_f32 v167, -v151
    v_cos_f32 v160, v152
    v_sin_f32 v168, -v152
    v_cos_f32 v161, v153
    v_sin_f32 v169, -v153
    v_cos_f32 v162, v154
    v_sin_f32 v170, -v154
    v_cos_f32 v163, v155
    v_sin_f32 v171, -v155
    s_nop 0
    v_cvt_pk_bf16_f32 v172, v156, v157
    v_cvt_pk_bf16_f32 v173, v158, v159
    v_cvt_pk_bf16_f32 v174, v160, v161
    v_cvt_pk_bf16_f32 v175, v162, v163
    v_cvt_pk_bf16_f32 v176, v164, v165
    v_cvt_pk_bf16_f32 v177, v166, v167
    v_cvt_pk_bf16_f32 v178, v168, v169
    v_cvt_pk_bf16_f32 v179, v170, v171
    s_waitcnt vmcnt(52)
    v_mfma_f32_16x16x32_bf16 v[48:51], a[24:27], v[180:183], v[48:51]
    v_mfma_f32_16x16x32_bf16 v[52:55], a[28:31], v[180:183], v[52:55]
    v_mfma_f32_16x16x32_bf16 v[56:59], a[32:35], v[180:183], v[56:59]
    v_mfma_f32_16x16x32_bf16 v[72:75], a[36:39], v[184:187], v[72:75]
    v_mfma_f32_16x16x32_bf16 v[76:79], a[40:43], v[184:187], v[76:79]
    v_mfma_f32_16x16x32_bf16 v[80:83], a[44:47], v[184:187], v[80:83]
    v_mfma_f32_16x16x32_bf16 v[96:99], a[24:27], v[144:147], v[96:99]
    v_mfma_f32_16x16x32_bf16 v[100:103], a[28:31], v[144:147], v[100:103]
    v_mfma_f32_16x16x32_bf16 v[104:107], a[32:35], v[144:147], v[104:107]
    buffer_load_dwordx4 a[24:27], v4, s[36:39], s68 offen offset:1024
    buffer_load_dwordx4 a[36:39], v4, s[36:39], s69 offen offset:1024
    buffer_load_dwordx4 a[28:31], v23, s[36:39], s68 offen offset:1024
    buffer_load_dwordx4 a[40:43], v23, s[36:39], s69 offen offset:1024
    buffer_load_dwordx4 a[32:35], v24, s[36:39], s68 offen offset:1024
    buffer_load_dwordx4 a[44:47], v24, s[36:39], s69 offen offset:1024
    v_add_f32 v148, v148, v41
    v_add_f32 v149, v149, v41
    v_add_f32 v150, v150, v41
    v_add_f32 v151, v151, v41
    v_add_f32 v152, v152, v41
    v_add_f32 v153, v153, v41
    v_add_f32 v154, v154, v41
    v_add_f32 v155, v155, v41
    v_cos_f32 v156, v148
    v_sin_f32 v164, -v148
    v_cos_f32 v157, v149
    v_sin_f32 v165, -v149
    v_cos_f32 v158, v150
    v_sin_f32 v166, -v150
    v_cos_f32 v159, v151
    v_sin_f32 v167, -v151
    v_cos_f32 v160, v152
    v_sin_f32 v168, -v152
    v_cos_f32 v161, v153
    v_sin_f32 v169, -v153
    v_cos_f32 v162, v154
    v_sin_f32 v170, -v154
    v_cos_f32 v163, v155
    v_sin_f32 v171, -v155
    s_nop 0
    v_cvt_pk_bf16_f32 v180, v156, v157
    v_cvt_pk_bf16_f32 v181, v158, v159
    v_cvt_pk_bf16_f32 v182, v160, v161
    v_cvt_pk_bf16_f32 v183, v162, v163
    v_cvt_pk_bf16_f32 v184, v164, v165
    v_cvt_pk_bf16_f32 v185, v166, v167
    v_cvt_pk_bf16_f32 v186, v168, v169
    v_cvt_pk_bf16_f32 v187, v170, v171
    s_waitcnt vmcnt(42)
    v_mfma_f32_16x16x32_bf16 v[48:51], a[48:51], v[172:175], v[48:51]
    v_mfma_f32_16x16x32_bf16 v[52:55], a[52:55], v[172:175], v[52:55]
    v_mfma_f32_16x16x32_bf16 v[56:59], a[56:59], v[172:175], v[56:59]
    v_mfma_f32_16x16x32_bf16 v[72:75], a[60:63], v[176:179], v[72:75]
    v_mfma_f32_16x16x32_bf16 v[76:79], a[64:67], v[176:179], v[76:79]
    v_mfma_f32_16x16x32_bf16 v[80:83], a[68:71], v[176:179], v[80:83]
    v_mfma_f32_16x16x32_bf16 v[96:99], a[48:51], v[144:147], v[96:99]
    v_mfma_f32_16x16x32_bf16 v[100:103], a[52:55], v[144:147], v[100:103]
    v_mfma_f32_16x16x32_bf16 v[104:107], a[56:59], v[144:147], v[104:107]
    buffer_load_dwordx4 a[48:51], v4, s[36:39], s68 offen offset:2048
    buffer_load_dwordx4 a[60:63], v4, s[36:39], s69 offen offset:2048
    buffer_load_dwordx4 a[52:55], v23, s[36:39], s68 offen offset:2048
    buffer_load_dwordx4 a[64:67], v23, s[36:39], s69 offen offset:2048
    buffer_load_dwordx4 a[56:59], v24, s[36:39], s68 offen offset:2048
    buffer_load_dwordx4 a[68:71], v24, s[36:39], s69 offen offset:2048
    v_add_f32 v148, v148, v41
    v_add_f32 v149, v149, v41
    v_add_f32 v150, v150, v41
    v_add_f32 v151, v151, v41
    v_add_f32 v152, v152, v41
    v_add_f32 v153, v153, v41
    v_add_f32 v154, v154, v41
    v_add_f32 v155, v155, v41
    v_cos_f32 v156, v148
    v_sin_f32 v164, -v148
    v_cos_f32 v157, v149
    v_sin_f32 v165, -v149
    v_cos_f32 v158, v150
    v_sin_f32 v166, -v150
    v_cos_f32 v159, v151
    v_sin_f32 v167, -v151
    v_cos_f32 v160, v152
    v_sin_f32 v168, -v152
    v_cos_f32 v161, v153
    v_sin_f32 v169, -v153
    v_cos_f32 v162, v154
    v_sin_f32 v170, -v154
    v_cos_f32 v163, v155
    v_sin_f32 v171, -v155
    s_nop 0
    v_cvt_pk_bf16_f32 v172, v156, v157
    v_cvt_pk_bf16_f32 v173, v158, v159
    v_cvt_pk_bf16_f32 v174, v160, v161
    v_cvt_pk_bf16_f32 v175, v162, v163
    v_cvt_pk_bf16_f32 v176, v164, v165
    v_cvt_pk_bf16_f32 v177, v166, v167
    v_cvt_pk_bf16_f32 v178, v168, v169
    v_cvt_pk_bf16_f32 v179, v170, v171
    s_waitcnt vmcnt(42)
    v_mfma_f32_16x16x32_bf16 v[48:51], a[72:75], v[180:183], v[48:51]
    v_mfma_f32_16x16x32_bf16 v[52:55], a[76:79], v[180:183], v[52:55]
    v_mfma_f32_16x16x32_bf16 v[56:59], a[80:83], v[180:183], v[56:59]
    v_mfma_f32_16x16x32_bf16 v[72:75], a[84:87], v[184:187], v[72:75]
    v_mfma_f32_16x16x32_bf16 v[76:79], a[88:91], v[184:187], v[76:79]
    v_mfma_f32_16x16x32_bf16 v[80:83], a[92:95], v[184:187], v[80:83]
    v_mfma_f32_16x16x32_bf16 v[96:99], a[72:75], v[144:147], v[96:99]
    v_mfma_f32_16x16x32_bf16 v[100:103], a[76:79], v[144:147], v[100:103]
    v_mfma_f32_16x16x32_bf16 v[104:107], a[80:83], v[144:147], v[104:107]
    buffer_load_dwordx4 a[72:75], v4, s[36:39], s68 offen offset:3072
    buffer_load_dwordx4 a[84:87], v4, s[36:39], s69 offen offset:3072
    buffer_load_dwordx4 a[76:79], v23, s[36:39], s68 offen offset:3072
    buffer_load_dwordx4 a[88:91], v23, s[36:39], s69 offen offset:3072
    buffer_load_dwordx4 a[80:83], v24, s[36:39], s68 offen offset:3072
    buffer_load_dwordx4 a[92:95], v24, s[36:39], s69 offen offset:3072
    v_add_f32 v148, v148, v41
    v_add_f32 v149, v149, v41
    v_add_f32 v150, v150, v41
    v_add_f32 v151, v151, v41
    v_add_f32 v152, v152, v41
    v_add_f32 v153, v153, v41
    v_add_f32 v154, v154, v41
    v_add_f32 v155, v155, v41
    v_cos_f32 v156, v148
    v_sin_f32 v164, -v148
    v_cos_f32 v157, v149
    v_sin_f32 v165, -v149
    v_cos_f32 v158, v150
    v_sin_f32 v166, -v150
    v_cos_f32 v159, v151
    v_sin_f32 v167, -v151
    v_cos_f32 v160, v152
    v_sin_f32 v168, -v152
    v_cos_f32 v161, v153
    v_sin_f32 v169, -v153
    v_cos_f32 v162, v154
    v_sin_f32 v170, -v154
    v_cos_f32 v163, v155
    v_sin_f32 v171, -v155
    s_nop 0
    v_cvt_pk_bf16_f32 v180, v156, v157
    v_cvt_pk_bf16_f32 v181, v158, v159
    v_cvt_pk_bf16_f32 v182, v160, v161
    v_cvt_pk_bf16_f32 v183, v162, v163
    v_cvt_pk_bf16_f32 v184, v164, v165
    v_cvt_pk_bf16_f32 v185, v166, v167
    v_cvt_pk_bf16_f32 v186, v168, v169
    v_cvt_pk_bf16_f32 v187, v170, v171
    s_waitcnt vmcnt(42)
    v_mfma_f32_16x16x32_bf16 v[48:51], a[96:99], v[172:175], v[48:51]
    v_mfma_f32_16x16x32_bf16 v[52:55], a[100:103], v[172:175], v[52:55]
    v_mfma_f32_16x16x32_bf16 v[56:59], a[104:107], v[172:175], v[56:59]
    v_mfma_f32_16x16x32_bf16 v[72:75], a[108:111], v[176:179], v[72:75]
    v_mfma_f32_16x16x32_bf16 v[76:79], a[112:115], v[176:179], v[76:79]
    v_mfma_f32_16x16x32_bf16 v[80:83], a[116:119], v[176:179], v[80:83]
    v_mfma_f32_16x16x32_bf16 v[96:99], a[96:99], v[144:147], v[96:99]
    v_mfma_f32_16x16x32_bf16 v[100:103], a[100:103], v[144:147], v[100:103]
    v_mfma_f32_16x16x32_bf16 v[104:107], a[104:107], v[144:147], v[104:107]
    s_add_u32 s68, s68, 0x1000
    s_add_u32 s69, s69, 0x1000
    buffer_load_dwordx4 a[96:99], v4, s[36:39], s68 offen offset:0
    buffer_load_dwordx4 a[108:111], v4, s[36:39], s69 offen offset:0
    buffer_load_dwordx4 a[100:103], v23, s[36:39], s68 offen offset:0
    buffer_load_dwordx4 a[112:115], v23, s[36:39], s69 offen offset:0
    buffer_load_dwordx4 a[104:107], v24, s[36:39], s68 offen offset:0
    buffer_load_dwordx4 a[116:119], v24, s[36:39], s69 offen offset:0
    v_add_f32 v148, v148, v41
    v_add_f32 v149, v149, v41
    v_add_f32 v150, v150, v41
    v_add_f32 v151, v151, v41
    v_add_f32 v152, v152, v41
    v_add_f32 v153, v153, v41
    v_add_f32 v154, v154, v41
    v_add_f32 v155, v155, v41
    v_cos_f32 v156, v148
    v_sin_f32 v164, -v148
    v_cos_f32 v157, v149
    v_sin_f32 v165, -v149
    v_cos_f32 v158, v150
    v_sin_f32 v166, -v150
    v_cos_f32 v159, v151
    v_sin_f32 v167, -v151
    v_cos_f32 v160, v152
    v_sin_f32 v168, -v152
    v_cos_f32 v161, v153
    v_sin_f32 v169, -v153
    v_cos_f32 v162, v154
    v_sin_f32 v170, -v154
    v_cos_f32 v163, v155
    v_sin_f32 v171, -v155
    s_nop 0
    v_cvt_pk_bf16_f32 v172, v156, v157
    v_cvt_pk_bf16_f32 v173, v158, v159
    v_cvt_pk_bf16_f32 v174, v160, v161
    v_cvt_pk_bf16_f32 v175, v162, v163
    v_cvt_pk_bf16_f32 v176, v164, v165
    v_cvt_pk_bf16_f32 v177, v166, v167
    v_cvt_pk_bf16_f32 v178, v168, v169
    v_cvt_pk_bf16_f32 v179, v170, v171
    s_waitcnt vmcnt(42)
    v_mfma_f32_16x16x32_bf16 v[48:51], a[120:123], v[180:183], v[48:51]
    v_mfma_f32_16x16x32_bf16 v[52:55], a[124:127], v[180:183], v[52:55]
    v_mfma_f32_16x16x32_bf16 v[56:59], a[128:131], v[180:183], v[56:59]
    v_mfma_f32_16x16x32_bf16 v[72:75], a[132:135], v[184:187], v[72:75]
    v_mfma_f32_16x16x32_bf16 v[76:79], a[136:139], v[184:187], v[76:79]
    v_mfma_f32_16x16x32_bf16 v[80:83], a[140:143], v[184:187], v[80:83]
    v_mfma_f32_16x16x32_bf16 v[96:99], a[120:123], v[144:147], v[96:99]
    v_mfma_f32_16x16x32_bf16 v[100:103], a[124:127], v[144:147], v[100:103]
    v_mfma_f32_16x16x32_bf16 v[104:107], a[128:131], v[144:147], v[104:107]
    buffer_load_dwordx4 a[120:123], v4, s[36:39], s68 offen offset:1024
    buffer_load_dwordx4 a[132:135], v4, s[36:39], s69 offen offset:1024
    buffer_load_dwordx4 a[124:127], v23, s[36:39], s68 offen offset:1024
    buffer_load_dwordx4 a[136:139], v23, s[36:39], s69 offen offset:1024
    buffer_load_dwordx4 a[128:131], v24, s[36:39], s68 offen offset:1024
    buffer_load_dwordx4 a[140:143], v24, s[36:39], s69 offen offset:1024
    v_add_f32 v148, v148, v41
    v_add_f32 v149, v149, v41
    v_add_f32 v150, v150, v41
    v_add_f32 v151, v151, v41
    v_add_f32 v152, v152, v41
    v_add_f32 v153, v153, v41
    v_add_f32 v154, v154, v41
    v_add_f32 v155, v155, v41
    v_cos_f32 v156, v148
    v_sin_f32 v164, -v148
    v_cos_f32 v157, v149
    v_sin_f32 v165, -v149
    v_cos_f32 v158, v150
    v_sin_f32 v166, -v150
    v_cos_f32 v159, v151
    v_sin_f32 v167, -v151
    v_cos_f32 v160, v152
    v_sin_f32 v168, -v152
    v_cos_f32 v161, v153
    v_sin_f32 v169, -v153
    v_cos_f32 v162, v154
    v_sin_f32 v170, -v154
    v_cos_f32 v163, v155
    v_sin_f32 v171, -v155
    s_nop 0
    v_cvt_pk_bf16_f32 v180, v156, v157
    v_cvt_pk_bf16_f32 v181, v158, v159
    v_cvt_pk_bf16_f32 v182, v160, v161
    v_cvt_pk_bf16_f32 v183, v162, v163
    v_cvt_pk_bf16_f32 v184, v164, v165
    v_cvt_pk_bf16_f32 v185, v166, v167
    v_cvt_pk_bf16_f32 v186, v168, v169
    v_cvt_pk_bf16_f32 v187, v170, v171
    s_waitcnt vmcnt(42)
    v_mfma_f32_16x16x32_bf16 v[48:51], a[144:147], v[172:175], v[48:51]
    v_mfma_f32_16x16x32_bf16 v[52:55], a[148:151], v[172:175], v[52:55]
    v_mfma_f32_16x16x32_bf16 v[56:59], a[152:155], v[172:175], v[56:59]
    v_mfma_f32_16x16x32_bf16 v[72:75], a[156:159], v[176:179], v[72:75]
    v_mfma_f32_16x16x32_bf16 v[76:79], a[160:163], v[176:179], v[76:79]
    v_mfma_f32_16x16x32_bf16 v[80:83], a[164:167], v[176:179], v[80:83]
    v_mfma_f32_16x16x32_bf16 v[96:99], a[144:147], v[144:147], v[96:99]
    v_mfma_f32_16x16x32_bf16 v[100:103], a[148:151], v[144:147], v[100:103]
    v_mfma_f32_16x16x32_bf16 v[104:107], a[152:155], v[144:147], v[104:107]
    buffer_load_dwordx4 a[144:147], v4, s[36:39], s68 offen offset:2048
    buffer_load_dwordx4 a[156:159], v4, s[36:39], s69 offen offset:2048
    buffer_load_dwordx4 a[148:151], v23, s[36:39], s68 offen offset:2048
    buffer_load_dwordx4 a[160:163], v23, s[36:39], s69 offen offset:2048
    buffer_load_dwordx4 a[152:155], v24, s[36:39], s68 offen offset:2048
    buffer_load_dwordx4 a[164:167], v24, s[36:39], s69 offen offset:2048
    v_add_u32 v39, 1, v38
    v_cvt_f32_u32 v39, v39
    v_mul_f32 v148, v39, v42
    v_add_u32 v39, 9, v38
    v_cvt_f32_u32 v39, v39
    v_mul_f32 v149, v39, v42
    v_add_u32 v39, 3, v38
    v_cvt_f32_u32 v39, v39
    v_mul_f32 v150, v39, v42
    v_add_u32 v39, 11, v38
    v_cvt_f32_u32 v39, v39
    v_mul_f32 v151, v39, v42
    v_add_u32 v39, 5, v38
    v_cvt_f32_u32 v39, v39
    v_mul_f32 v152, v39, v42
    v_add_u32 v39, 13, v38
    v_cvt_f32_u32 v39, v39
    v_mul_f32 v153, v39, v42
    v_add_u32 v39, 7, v38
    v_cvt_f32_u32 v39, v39
    v_mul_f32 v154, v39, v42
    v_add_u32 v39, 15, v38
    v_cvt_f32_u32 v39, v39
    v_mul_f32 v155, v39, v42
    v_cos_f32 v156, v148
    v_sin_f32 v164, -v148
    v_cos_f32 v157, v149
    v_sin_f32 v165, -v149
    v_cos_f32 v158, v150
    v_sin_f32 v166, -v150
    v_cos_f32 v159, v151
    v_sin_f32 v167, -v151
    v_cos_f32 v160, v152
    v_sin_f32 v168, -v152
    v_cos_f32 v161, v153
    v_sin_f32 v169, -v153
    v_cos_f32 v162, v154
    v_sin_f32 v170, -v154
    v_cos_f32 v163, v155
    v_sin_f32 v171, -v155
    s_nop 0
    v_cvt_pk_bf16_f32 v172, v156, v157
    v_cvt_pk_bf16_f32 v173, v158, v159
    v_cvt_pk_bf16_f32 v174, v160, v161
    v_cvt_pk_bf16_f32 v175, v162, v163
    v_cvt_pk_bf16_f32 v176, v164, v165
    v_cvt_pk_bf16_f32 v177, v166, v167
    v_cvt_pk_bf16_f32 v178, v168, v169
    v_cvt_pk_bf16_f32 v179, v170, v171
    s_waitcnt vmcnt(42)
    v_mfma_f32_16x16x32_bf16 v[48:51], a[168:171], v[180:183], v[48:51]
    v_mfma_f32_16x16x32_bf16 v[52:55], a[172:175], v[180:183], v[52:55]
    v_mfma_f32_16x16x32_bf16 v[56:59], a[176:179], v[180:183], v[56:59]
    v_mfma_f32_16x16x32_bf16 v[72:75], a[180:183], v[184:187], v[72:75]
    v_mfma_f32_16x16x32_bf16 v[76:79], a[184:187], v[184:187], v[76:79]
    v_mfma_f32_16x16x32_bf16 v[80:83], a[188:191], v[184:187], v[80:83]
    v_mfma_f32_16x16x32_bf16 v[96:99], a[168:171], v[144:147], v[96:99]
    v_mfma_f32_16x16x32_bf16 v[100:103], a[172:175], v[144:147], v[100:103]
    v_mfma_f32_16x16x32_bf16 v[104:107], a[176:179], v[144:147], v[104:107]
    buffer_load_dwordx4 a[168:171], v4, s[36:39], s68 offen offset:3072
    buffer_load_dwordx4 a[180:183], v4, s[36:39], s69 offen offset:3072
    buffer_load_dwordx4 a[172:175], v23, s[36:39], s68 offen offset:3072
    buffer_load_dwordx4 a[184:187], v23, s[36:39], s69 offen offset:3072
    buffer_load_dwordx4 a[176:179], v24, s[36:39], s68 offen offset:3072
    buffer_load_dwordx4 a[188:191], v24, s[36:39], s69 offen offset:3072
    v_add_f32 v148, v148, v41
    v_add_f32 v149, v149, v41
    v_add_f32 v150, v150, v41
    v_add_f32 v151, v151, v41
    v_add_f32 v152, v152, v41
    v_add_f32 v153, v153, v41
    v_add_f32 v154, v154, v41
    v_add_f32 v155, v155, v41
    v_cos_f32 v156, v148
    v_sin_f32 v164, -v148
    v_cos_f32 v157, v149
    v_sin_f32 v165, -v149
    v_cos_f32 v158, v150
    v_sin_f32 v166, -v150
    v_cos_f32 v159, v151
    v_sin_f32 v167, -v151
    v_cos_f32 v160, v152
    v_sin_f32 v168, -v152
    v_cos_f32 v161, v153
    v_sin_f32 v169, -v153
    v_cos_f32 v162, v154
    v_sin_f32 v170, -v154
    v_cos_f32 v163, v155
    v_sin_f32 v171, -v155
    s_nop 0
    v_cvt_pk_bf16_f32 v180, v156, v157
    v_cvt_pk_bf16_f32 v181, v158, v159
    v_cvt_pk_bf16_f32 v182, v160, v161
    v_cvt_pk_bf16_f32 v183, v162, v163
    v_cvt_pk_bf16_f32 v184, v164, v165
    v_cvt_pk_bf16_f32 v185, v166, v167
    v_cvt_pk_bf16_f32 v186, v168, v169
    v_cvt_pk_bf16_f32 v187, v170, v171
    s_waitcnt vmcnt(42)
    v_mfma_f32_16x16x32_bf16 v[60:63], a[0:3], v[172:175], 0
    v_mfma_f32_16x16x32_bf16 v[64:67], a[4:7], v[172:175], 0
    v_mfma_f32_16x16x32_bf16 v[68:71], a[8:11], v[172:175], 0
    v_mfma_f32_16x16x32_bf16 v[84:87], a[12:15], v[176:179], 0
    v_mfma_f32_16x16x32_bf16 v[88:91], a[16:19], v[176:179], 0
    v_mfma_f32_16x16x32_bf16 v[92:95], a[20:23], v[176:179], 0
    v_mfma_f32_16x16x32_bf16 v[108:111], a[12:15], v[144:147], 0
    v_mfma_f32_16x16x32_bf16 v[112:115], a[16:19], v[144:147], 0
    v_mfma_f32_16x16x32_bf16 v[116:119], a[20:23], v[144:147], 0
    v_add_f32 v148, v148, v41
    v_add_f32 v149, v149, v41
    v_add_f32 v150, v150, v41
    v_add_f32 v151, v151, v41
    v_add_f32 v152, v152, v41
    v_add_f32 v153, v153, v41
    v_add_f32 v154, v154, v41
    v_add_f32 v155, v155, v41
    v_cos_f32 v156, v148
    v_sin_f32 v164, -v148
    v_cos_f32 v157, v149
    v_sin_f32 v165, -v149
    v_cos_f32 v158, v150
    v_sin_f32 v166, -v150
    v_cos_f32 v159, v151
    v_sin_f32 v167, -v151
    v_cos_f32 v160, v152
    v_sin_f32 v168, -v152
    v_cos_f32 v161, v153
    v_sin_f32 v169, -v153
    v_cos_f32 v162, v154
    v_sin_f32 v170, -v154
    v_cos_f32 v163, v155
    v_sin_f32 v171, -v155
    s_nop 0
    v_cvt_pk_bf16_f32 v172, v156, v157
    v_cvt_pk_bf16_f32 v173, v158, v159
    v_cvt_pk_bf16_f32 v174, v160, v161
    v_cvt_pk_bf16_f32 v175, v162, v163
    v_cvt_pk_bf16_f32 v176, v164, v165
    v_cvt_pk_bf16_f32 v177, v166, v167
    v_cvt_pk_bf16_f32 v178, v168, v169
    v_cvt_pk_bf16_f32 v179, v170, v171
    s_waitcnt vmcnt(36)
    v_mfma_f32_16x16x32_bf16 v[60:63], a[24:27], v[180:183], v[60:63]
    v_mfma_f32_16x16x32_bf16 v[64:67], a[28:31], v[180:183], v[64:67]
    v_mfma_f32_16x16x32_bf16 v[68:71], a[32:35], v[180:183], v[68:71]
    v_mfma_f32_16x16x32_bf16 v[84:87], a[36:39], v[184:187], v[84:87]
    v_mfma_f32_16x16x32_bf16 v[88:91], a[40:43], v[184:187], v[88:91]
    v_mfma_f32_16x16x32_bf16 v[92:95], a[44:47], v[184:187], v[92:95]
    v_mfma_f32_16x16x32_bf16 v[108:111], a[36:39], v[144:147], v[108:111]
    v_mfma_f32_16x16x32_bf16 v[112:115], a[40:43], v[144:147], v[112:115]
    v_mfma_f32_16x16x32_bf16 v[116:119], a[44:47], v[144:147], v[116:119]
    v_add_f32 v148, v148, v41
    v_add_f32 v149, v149, v41
    v_add_f32 v150, v150, v41
    v_add_f32 v151, v151, v41
    v_add_f32 v152, v152, v41
    v_add_f32 v153, v153, v41
    v_add_f32 v154, v154, v41
    v_add_f32 v155, v155, v41
    v_cos_f32 v156, v148
    v_sin_f32 v164, -v148
    v_cos_f32 v157, v149
    v_sin_f32 v165, -v149
    v_cos_f32 v158, v150
    v_sin_f32 v166, -v150
    v_cos_f32 v159, v151
    v_sin_f32 v167, -v151
    v_cos_f32 v160, v152
    v_sin_f32 v168, -v152
    v_cos_f32 v161, v153
    v_sin_f32 v169, -v153
    v_cos_f32 v162, v154
    v_sin_f32 v170, -v154
    v_cos_f32 v163, v155
    v_sin_f32 v171, -v155
    s_nop 0
    v_cvt_pk_bf16_f32 v180, v156, v157
    v_cvt_pk_bf16_f32 v181, v158, v159
    v_cvt_pk_bf16_f32 v182, v160, v161
    v_cvt_pk_bf16_f32 v183, v162, v163
    v_cvt_pk_bf16_f32 v184, v164, v165
    v_cvt_pk_bf16_f32 v185, v166, v167
    v_cvt_pk_bf16_f32 v186, v168, v169
    v_cvt_pk_bf16_f32 v187, v170, v171
    s_waitcnt vmcnt(30)
    v_mfma_f32_16x16x32_bf16 v[60:63], a[48:51], v[172:175], v[60:63]
    v_mfma_f32_16x16x32_bf16 v[64:67], a[52:55], v[172:175], v[64:67]
    v_mfma_f32_16x16x32_bf16 v[68:71], a[56:59], v[172:175], v[68:71]
    v_mfma_f32_16x16x32_bf16 v[84:87], a[60:63], v[176:179], v[84:87]
    v_mfma_f32_16x16x32_bf16 v[88:91], a[64:67], v[176:179], v[88:91]
    v_mfma_f32_16x16x32_bf16 v[92:95], a[68:71], v[176:179], v[92:95]
    v_mfma_f32_16x16x32_bf16 v[108:111], a[60:63], v[144:147], v[108:111]
    v_mfma_f32_16x16x32_bf16 v[112:115], a[64:67], v[144:147], v[112:115]
    v_mfma_f32_16x16x32_bf16 v[116:119], a[68:71], v[144:147], v[116:119]
    v_add_f32 v148, v148, v41
    v_add_f32 v149, v149, v41
    v_add_f32 v150, v150, v41
    v_add_f32 v151, v151, v41
    v_add_f32 v152, v152, v41
    v_add_f32 v153, v153, v41
    v_add_f32 v154, v154, v41
    v_add_f32 v155, v155, v41
    v_cos_f32 v156, v148
    v_sin_f32 v164, -v148
    v_cos_f32 v157, v149
    v_sin_f32 v165, -v149
    v_cos_f32 v158, v150
    v_sin_f32 v166, -v150
    v_cos_f32 v159, v151
    v_sin_f32 v167, -v151
    v_cos_f32 v160, v152
    v_sin_f32 v168, -v152
    v_cos_f32 v161, v153
    v_sin_f32 v169, -v153
    v_cos_f32 v162, v154
    v_sin_f32 v170, -v154
    v_cos_f32 v163, v155
    v_sin_f32 v171, -v155
    s_nop 0
    v_cvt_pk_bf16_f32 v172, v156, v157
    v_cvt_pk_bf16_f32 v173, v158, v159
    v_cvt_pk_bf16_f32 v174, v160, v161
    v_cvt_pk_bf16_f32 v175, v162, v163
    v_cvt_pk_bf16_f32 v176, v164, v165
    v_cvt_pk_bf16_f32 v177, v166, v167
    v_cvt_pk_bf16_f32 v178, v168, v169
    v_cvt_pk_bf16_f32 v179, v170, v171
    s_waitcnt vmcnt(24)
    v_mfma_f32_16x16x32_bf16 v[60:63], a[72:75], v[180:183], v[60:63]
    v_mfma_f32_16x16x32_bf16 v[64:67], a[76:79], v[180:183], v[64:67]
    v_mfma_f32_16x16x32_bf16 v[68:71], a[80:83], v[180:183], v[68:71]
    v_mfma_f32_16x16x32_bf16 v[84:87], a[84:87], v[184:187], v[84:87]
    v_mfma_f32_16x16x32_bf16 v[88:91], a[88:91], v[184:187], v[88:91]
    v_mfma_f32_16x16x32_bf16 v[92:95], a[92:95], v[184:187], v[92:95]
    v_mfma_f32_16x16x32_bf16 v[108:111], a[84:87], v[144:147], v[108:111]
    v_mfma_f32_16x16x32_bf16 v[112:115], a[88:91], v[144:147], v[112:115]
    v_mfma_f32_16x16x32_bf16 v[116:119], a[92:95], v[144:147], v[116:119]
    v_add_f32 v148, v148, v41
    v_add_f32 v149, v149, v41
    v_add_f32 v150, v150, v41
    v_add_f32 v151, v151, v41
    v_add_f32 v152, v152, v41
    v_add_f32 v153, v153, v41
    v_add_f32 v154, v154, v41
    v_add_f32 v155, v155, v41
    v_cos_f32 v156, v148
    v_sin_f32 v164, -v148
    v_cos_f32 v157, v149
    v_sin_f32 v165, -v149
    v_cos_f32 v158, v150
    v_sin_f32 v166, -v150
    v_cos_f32 v159, v151
    v_sin_f32 v167, -v151
    v_cos_f32 v160, v152
    v_sin_f32 v168, -v152
    v_cos_f32 v161, v153
    v_sin_f32 v169, -v153
    v_cos_f32 v162, v154
    v_sin_f32 v170, -v154
    v_cos_f32 v163, v155
    v_sin_f32 v171, -v155
    s_nop 0
    v_cvt_pk_bf16_f32 v180, v156, v157
    v_cvt_pk_bf16_f32 v181, v158, v159
    v_cvt_pk_bf16_f32 v182, v160, v161
    v_cvt_pk_bf16_f32 v183, v162, v163
    v_cvt_pk_bf16_f32 v184, v164, v165
    v_cvt_pk_bf16_f32 v185, v166, v167
    v_cvt_pk_bf16_f32 v186, v168, v169
    v_cvt_pk_bf16_f32 v187, v170, v171
    s_waitcnt vmcnt(18)
    v_mfma_f32_16x16x32_bf16 v[60:63], a[96:99], v[172:175], v[60:63]
    v_mfma_f32_16x16x32_bf16 v[64:67], a[100:103], v[172:175], v[64:67]
    v_mfma_f32_16x16x32_bf16 v[68:71], a[104:107], v[172:175], v[68:71]
    v_mfma_f32_16x16x32_bf16 v[84:87], a[108:111], v[176:179], v[84:87]
    v_mfma_f32_16x16x32_bf16 v[88:91], a[112:115], v[176:179], v[88:91]
    v_mfma_f32_16x16x32_bf16 v[92:95], a[116:119], v[176:179], v[92:95]
    v_mfma_f32_16x16x32_bf16 v[108:111], a[108:111], v[144:147], v[108:111]
    v_mfma_f32_16x16x32_bf16 v[112:115], a[112:115], v[144:147], v[112:115]
    v_mfma_f32_16x16x32_bf16 v[116:119], a[116:119], v[144:147], v[116:119]
    v_add_f32 v148, v148, v41
    v_add_f32 v149, v149, v41
    v_add_f32 v150, v150, v41
    v_add_f32 v151, v151, v41
    v_add_f32 v152, v152, v41
    v_add_f32 v153, v153, v41
    v_add_f32 v154, v154, v41
    v_add_f32 v155, v155, v41
    v_cos_f32 v156, v148
    v_sin_f32 v164, -v148
    v_cos_f32 v157, v149
    v_sin_f32 v165, -v149
    v_cos_f32 v158, v150
    v_sin_f32 v166, -v150
    v_cos_f32 v159, v151
    v_sin_f32 v167, -v151
    v_cos_f32 v160, v152
    v_sin_f32 v168, -v152
    v_cos_f32 v161, v153
    v_sin_f32 v169, -v153
    v_cos_f32 v162, v154
    v_sin_f32 v170, -v154
    v_cos_f32 v163, v155
    v_sin_f32 v171, -v155
    s_nop 0
    v_cvt_pk_bf16_f32 v172, v156, v157
    v_cvt_pk_bf16_f32 v173, v158, v159
    v_cvt_pk_bf16_f32 v174, v160, v161
    v_cvt_pk_bf16_f32 v175, v162, v163
    v_cvt_pk_bf16_f32 v176, v164, v165
    v_cvt_pk_bf16_f32 v177, v166, v167
    v_cvt_pk_bf16_f32 v178, v168, v169
    v_cvt_pk_bf16_f32 v179, v170, v171
    s_waitcnt vmcnt(12)
    v_mfma_f32_16x16x32_bf16 v[60:63], a[120:123], v[180:183], v[60:63]
    v_mfma_f32_16x16x32_bf16 v[64:67], a[124:127], v[180:183], v[64:67]
    v_mfma_f32_16x16x32_bf16 v[68:71], a[128:131], v[180:183], v[68:71]
    v_mfma_f32_16x16x32_bf16 v[84:87], a[132:135], v[184:187], v[84:87]
    v_mfma_f32_16x16x32_bf16 v[88:91], a[136:139], v[184:187], v[88:91]
    v_mfma_f32_16x16x32_bf16 v[92:95], a[140:143], v[184:187], v[92:95]
    v_mfma_f32_16x16x32_bf16 v[108:111], a[132:135], v[144:147], v[108:111]
    v_mfma_f32_16x16x32_bf16 v[112:115], a[136:139], v[144:147], v[112:115]
    v_mfma_f32_16x16x32_bf16 v[116:119], a[140:143], v[144:147], v[116:119]
    v_add_f32 v148, v148, v41
    v_add_f32 v149, v149, v41
    v_add_f32 v150, v150, v41
    v_add_f32 v151, v151, v41
    v_add_f32 v152, v152, v41
    v_add_f32 v153, v153, v41
    v_add_f32 v154, v154, v41
    v_add_f32 v155, v155, v41
    v_cos_f32 v156, v148
    v_sin_f32 v164, -v148
    v_cos_f32 v157, v149
    v_sin_f32 v165, -v149
    v_cos_f32 v158, v150
    v_sin_f32 v166, -v150
    v_cos_f32 v159, v151
    v_sin_f32 v167, -v151
    v_cos_f32 v160, v152
    v_sin_f32 v168, -v152
    v_cos_f32 v161, v153
    v_sin_f32 v169, -v153
    v_cos_f32 v162, v154
    v_sin_f32 v170, -v154
    v_cos_f32 v163, v155
    v_sin_f32 v171, -v155
    s_nop 0
    v_cvt_pk_bf16_f32 v180, v156, v157
    v_cvt_pk_bf16_f32 v181, v158, v159
    v_cvt_pk_bf16_f32 v182, v160, v161
    v_cvt_pk_bf16_f32 v183, v162, v163
    v_cvt_pk_bf16_f32 v184, v164, v165
    v_cvt_pk_bf16_f32 v185, v166, v167
    v_cvt_pk_bf16_f32 v186, v168, v169
    v_cvt_pk_bf16_f32 v187, v170, v171
    s_waitcnt vmcnt(6)
    v_mfma_f32_16x16x32_bf16 v[60:63], a[144:147], v[172:175], v[60:63]
    v_mfma_f32_16x16x32_bf16 v[64:67], a[148:151], v[172:175], v[64:67]
    v_mfma_f32_16x16x32_bf16 v[68:71], a[152:155], v[172:175], v[68:71]
    v_mfma_f32_16x16x32_bf16 v[84:87], a[156:159], v[176:179], v[84:87]
    v_mfma_f32_16x16x32_bf16 v[88:91], a[160:163], v[176:179], v[88:91]
    v_mfma_f32_16x16x32_bf16 v[92:95], a[164:167], v[176:179], v[92:95]
    v_mfma_f32_16x16x32_bf16 v[108:111], a[156:159], v[144:147], v[108:111]
    v_mfma_f32_16x16x32_bf16 v[112:115], a[160:163], v[144:147], v[112:115]
    v_mfma_f32_16x16x32_bf16 v[116:119], a[164:167], v[144:147], v[116:119]
    s_nop 1
    s_waitcnt vmcnt(0)
    v_mfma_f32_16x16x32_bf16 v[60:63], a[168:171], v[180:183], v[60:63]
    v_mfma_f32_16x16x32_bf16 v[64:67], a[172:175], v[180:183], v[64:67]
    v_mfma_f32_16x16x32_bf16 v[68:71], a[176:179], v[180:183], v[68:71]
    v_mfma_f32_16x16x32_bf16 v[84:87], a[180:183], v[184:187], v[84:87]
    v_mfma_f32_16x16x32_bf16 v[88:91], a[184:187], v[184:187], v[88:91]
    v_mfma_f32_16x16x32_bf16 v[92:95], a[188:191], v[184:187], v[92:95]
    v_mfma_f32_16x16x32_bf16 v[108:111], a[180:183], v[144:147], v[108:111]
    v_mfma_f32_16x16x32_bf16 v[112:115], a[184:187], v[144:147], v[112:115]
    v_mfma_f32_16x16x32_bf16 v[116:119], a[188:191], v[144:147], v[116:119]
    s_cmp_eq_u32 s53, 0
    s_cselect_b32 s72, 0xffff, 0
    s_mov_b32 s73, 0
    s_cmp_eq_u32 s53, 7
    s_cselect_b32 s74, 0xffff, 0
    s_mov_b32 s75, 0
    v_mul_u32_u24 v30, 208, v2
    v_add3_u32 v30, v30, v37, 0
    v_add_u32 v30, 52224, v30
    s_nop 5
    v_fma_f32 v48, v43, v120, v48
    v_fma_f32 v72, v44, v132, v72
    v_fma_f32 v49, v43, v121, v49
    v_fma_f32 v73, v44, v133, v73
    v_fma_f32 v50, v43, v122, v50
    v_fma_f32 v74, v44, v134, v74
    v_fma_f32 v51, v43, v123, v51
    v_fma_f32 v75, v44, v135, v75
    v_cndmask_b32 v72, v72, 0, s[72:73]
    v_cndmask_b32 v84, v84, 0, s[72:73]
    v_cndmask_b32 v108, v108, 0, s[72:73]
    v_add_f32 v156, v48, v60
    v_sub_f32 v164, v48, v60
    v_add_f32 v48, v72, v84
    v_sub_f32 v60, v84, v72
    v_add_f32 v157, v49, v61
    v_sub_f32 v165, v49, v61
    v_add_f32 v49, v73, v85
    v_sub_f32 v61, v85, v73
    v_add_f32 v158, v50, v62
    v_sub_f32 v166, v50, v62
    v_add_f32 v50, v74, v86
    v_sub_f32 v62, v86, v74
    v_add_f32 v159, v51, v63
    v_sub_f32 v167, v51, v63
    v_add_f32 v51, v75, v87
    v_sub_f32 v63, v87, v75
    v_add_f32 v160, v156, v48
    v_sub_f32 v156, v156, v48
    v_add_f32 v168, v164, v60
    v_sub_f32 v164, v164, v60
    v_add_f32 v161, v157, v49
    v_sub_f32 v157, v157, v49
    v_add_f32 v169, v165, v61
    v_sub_f32 v165, v165, v61
    v_add_f32 v162, v158, v50
    v_sub_f32 v158, v158, v50
    v_add_f32 v170, v166, v62
    v_sub_f32 v166, v166, v62
    v_add_f32 v163, v159, v51
    v_sub_f32 v159, v159, v51
    v_add_f32 v171, v167, v63
    v_sub_f32 v167, v167, v63
    ds_write_b128 v30, v[156:159] offset:0
    ds_write_b128 v30, v[160:163] offset:3536
    ds_write_b128 v30, v[164:167] offset:7072
    ds_write_b128 v30, v[168:171] offset:10608
    v_fma_f32 v52, v43, v124, v52
    v_fma_f32 v76, v44, v136, v76
    v_fma_f32 v53, v43, v125, v53
    v_fma_f32 v77, v44, v137, v77
    v_fma_f32 v54, v43, v126, v54
    v_fma_f32 v78, v44, v138, v78
    v_fma_f32 v55, v43, v127, v55
    v_fma_f32 v79, v44, v139, v79
    v_add_f32 v172, v52, v64
    v_sub_f32 v180, v52, v64
    v_add_f32 v52, v76, v88
    v_sub_f32 v64, v88, v76
    v_add_f32 v173, v53, v65
    v_sub_f32 v181, v53, v65
    v_add_f32 v53, v77, v89
    v_sub_f32 v65, v89, v77
    v_add_f32 v174, v54, v66
    v_sub_f32 v182, v54, v66
    v_add_f32 v54, v78, v90
    v_sub_f32 v66, v90, v78
    v_add_f32 v175, v55, v67
    v_sub_f32 v183, v55, v67
    v_add_f32 v55, v79, v91
    v_sub_f32 v67, v91, v79
    v_add_f32 v176, v172, v52
    v_sub_f32 v172, v172, v52
    v_add_f32 v184, v180, v64
    v_sub_f32 v180, v180, v64
    v_add_f32 v177, v173, v53
    v_sub_f32 v173, v173, v53
    v_add_f32 v185, v181, v65
    v_sub_f32 v181, v181, v65
    v_add_f32 v178, v174, v54
    v_sub_f32 v174, v174, v54
    v_add_f32 v186, v182, v66
    v_sub_f32 v182, v182, v66
    v_add_f32 v179, v175, v55
    v_sub_f32 v175, v175, v55
    v_add_f32 v187, v183, v67
    v_sub_f32 v183, v183, v67
    ds_write_b128 v30, v[172:175] offset:64
    ds_write_b128 v30, v[176:179] offset:3600
    ds_write_b128 v30, v[180:183] offset:7136
    ds_write_b128 v30, v[184:187] offset:10672
    v_fma_f32 v56, v43, v128, v56
    v_fma_f32 v80, v44, v140, v80
    v_fma_f32 v57, v43, v129, v57
    v_fma_f32 v81, v44, v141, v81
    v_fma_f32 v58, v43, v130, v58
    v_fma_f32 v82, v44, v142, v82
    v_fma_f32 v59, v43, v131, v59
    v_fma_f32 v83, v44, v143, v83
    v_cndmask_b32 v80, v80, 0, s[74:75]
    v_cndmask_b32 v92, v92, 0, s[74:75]
    v_cndmask_b32 v116, v116, 0, s[74:75]
    v_add_f32 v156, v56, v68
    v_sub_f32 v164, v56, v68
    v_add_f32 v56, v80, v92
    v_sub_f32 v68, v92, v80
    v_add_f32 v157, v57, v69
    v_sub_f32 v165, v57, v69
    v_add_f32 v57, v81, v93
    v_sub_f32 v69, v93, v81
    v_add_f32 v158, v58, v70
    v_sub_f32 v166, v58, v70
    v_add_f32 v58, v82, v94
    v_sub_f32 v70, v94, v82
    v_add_f32 v159, v59, v71
    v_sub_f32 v167, v59, v71
    v_add_f32 v59, v83, v95
    v_sub_f32 v71, v95, v83
    v_add_f32 v160, v156, v56
    v_sub_f32 v156, v156, v56
    v_add_f32 v168, v164, v68
    v_sub_f32 v164, v164, v68
    v_add_f32 v161, v157, v57
    v_sub_f32 v157, v157, v57
    v_add_f32 v169, v165, v69
    v_sub_f32 v165, v165, v69
    v_add_f32 v162, v158, v58
    v_sub_f32 v158, v158, v58
    v_add_f32 v170, v166, v70
    v_sub_f32 v166, v166, v70
    v_add_f32 v163, v159, v59
    v_sub_f32 v159, v159, v59
    v_add_f32 v171, v167, v71
    v_sub_f32 v167, v167, v71
    ds_write_b128 v30, v[156:159] offset:128
    ds_write_b128 v30, v[160:163] offset:3664
    ds_write_b128 v30, v[164:167] offset:7200
    ds_write_b128 v30, v[168:171] offset:10736
    v_add_f32 v96, v96, v120
    v_sub_f32 v120, v96, v108
    v_add_f32 v96, v96, v108
    v_add_f32 v97, v97, v121
    v_sub_f32 v121, v97, v109
    v_add_f32 v97, v97, v109
    v_add_f32 v98, v98, v122
    v_sub_f32 v122, v98, v110
    v_add_f32 v98, v98, v110
    v_add_f32 v99, v99, v123
    v_sub_f32 v123, v99, v111
    v_add_f32 v99, v99, v111
    v_add_f32 v100, v100, v124
    v_sub_f32 v124, v100, v112
    v_add_f32 v100, v100, v112
    v_add_f32 v101, v101, v125
    v_sub_f32 v125, v101, v113
    v_add_f32 v101, v101, v113
    v_add_f32 v102, v102, v126
    v_sub_f32 v126, v102, v114
    v_add_f32 v102, v102, v114
    v_add_f32 v103, v103, v127
    v_sub_f32 v127, v103, v115
    v_add_f32 v103, v103, v115
    v_add_f32 v104, v104, v128
    v_sub_f32 v128, v104, v116
    v_add_f32 v104, v104, v116
    v_add_f32 v105, v105, v129
    v_sub_f32 v129, v105, v117
    v_add_f32 v105, v105, v117
    v_add_f32 v106, v106, v130
    v_sub_f32 v130, v106, v118
    v_add_f32 v106, v106, v118
    v_add_f32 v107, v107, v131
    v_sub_f32 v131, v107, v119
    v_add_f32 v107, v107, v119
    v_cmp_eq_u32 vcc, 0, v2
    s_and_saveexec_b64 s[76:77], vcc
    ds_write_b128 v30, v[96:99] offset:3328
    ds_write_b128 v30, v[120:123] offset:6864
    ds_write_b128 v30, v[100:103] offset:3392
    ds_write_b128 v30, v[124:127] offset:6928
    ds_write_b128 v30, v[104:107] offset:3456
    ds_write_b128 v30, v[128:131] offset:6992
    s_mov_b64 exec, s[76:77]
K2_FINAL:
    v_lshrrev_b32 v31, 2, v1
    s_lshl_b32 s66, s54, 4
    v_add_u32 v32, s66, v31
    v_mul_u32_u24 v32, 272, v32
    v_and_b32 v33, 3, v1
    v_lshl_add_u32 v32, v33, 5, v32
    v_and_b32 v34, 3, v31
    s_lshl_b32 s66, s54, 2
    v_add_u32 v35, s66, v3
    v_or_b32 v36, s57, v35
    v_cmp_eq_u32 vcc, 0, v36
    v_lshlrev_b32 v38, 1, v34
    v_mov_b32 v39, 0x48
    v_lshrrev_b32 v39, v38, v39
    v_and_b32 v39, 3, v39
    v_and_b32 v38, 2, v34
    v_lshlrev_b32 v38, 3, v38
    v_cndmask_b32 v34, v34, v39, vcc
    v_cndmask_b32 v35, v35, v38, vcc
    v_mul_u32_u24 v35, 208, v35
    v_add_u32 v35, 52224, v35
    v_mov_b32 v38, 3536
    v_mad_u32_u24 v36, v34, v38, v35
    v_lshl_add_u32 v36, v33, 5, v36
    v_xor_b32 v34, 1, v34
    v_mad_u32_u24 v35, v34, v38, v35
    v_lshlrev_b32 v33, 5, v33
    v_sub_u32 v35, v35, v33
    s_waitcnt vmcnt(0) lgkmcnt(0)
    s_barrier
    ds_read_b128 v[48:51], v32 offset:0
    ds_read_b128 v[52:55], v32 offset:16
    ds_read_b128 v[56:59], v32 offset:17408
    ds_read_b128 v[60:63], v32 offset:17424
    ds_read_b128 v[64:67], v32 offset:34816
    ds_read_b128 v[68:71], v32 offset:34832
    ds_read_b128 v[120:123], v36
    ds_read_b128 v[124:127], v36 offset:16
    ds_read_b128 v[72:75], v32 offset:128
    ds_read_b128 v[76:79], v32 offset:144
    ds_read_b128 v[80:83], v32 offset:17536
    ds_read_b128 v[84:87], v32 offset:17552
    ds_read_b128 v[88:91], v32 offset:34944
    ds_read_b128 v[92:95], v32 offset:34960
    s_waitcnt lgkmcnt(6)
    ds_read_b32 v128, v35 offset:128
    ds_read_b32 v129, v35 offset:124
    ds_read_b32 v130, v35 offset:120
    ds_read_b32 v131, v35 offset:116
    ds_read_b32 v132, v35 offset:112
    ds_read_b32 v133, v35 offset:108
    ds_read_b32 v134, v35 offset:104
    ds_read_b32 v135, v35 offset:100
    v_lshlrev_b32 v136, 16, v14
    v_and_b32 v137, 0xffff0000, v14
    v_lshlrev_b32 v138, 16, v15
    v_and_b32 v139, 0xffff0000, v15
    v_lshlrev_b32 v140, 16, v16
    v_and_b32 v141, 0xffff0000, v16
    v_lshlrev_b32 v142, 16, v17
    v_and_b32 v143, 0xffff0000, v17
    v_pk_add_f32 v[48:49], v[48:49], v[56:57]
    v_pk_add_f32 v[136:137], v[136:137], v[64:65]
    v_pk_add_f32 v[50:51], v[50:51], v[58:59]
    v_pk_add_f32 v[138:139], v[138:139], v[66:67]
    v_pk_add_f32 v[52:53], v[52:53], v[60:61]
    v_pk_add_f32 v[140:141], v[140:141], v[68:69]
    v_pk_add_f32 v[54:55], v[54:55], v[62:63]
    v_pk_add_f32 v[142:143], v[142:143], v[70:71]
    v_pk_add_f32 v[136:137], v[136:137], v[48:49]
    v_pk_add_f32 v[138:139], v[138:139], v[50:51]
    v_pk_add_f32 v[140:141], v[140:141], v[52:53]
    v_pk_add_f32 v[142:143], v[142:143], v[54:55]
    v_mul_f32 v144, 0xbfb8aa3b, v136
    v_mul_f32 v145, 0xbfb8aa3b, v137
    v_mul_f32 v146, 0xbfb8aa3b, v138
    v_mul_f32 v147, 0xbfb8aa3b, v139
    v_mul_f32 v148, 0xbfb8aa3b, v140
    v_mul_f32 v149, 0xbfb8aa3b, v141
    v_mul_f32 v150, 0xbfb8aa3b, v142
    v_mul_f32 v151, 0xbfb8aa3b, v143
    v_exp_f32 v144, v144
    v_exp_f32 v145, v145
    v_exp_f32 v146, v146
    v_exp_f32 v147, v147
    v_exp_f32 v148, v148
    v_exp_f32 v149, v149
    v_exp_f32 v150, v150
    v_exp_f32 v151, v151
    v_lshlrev_b32 v152, 16, v6
    v_and_b32 v153, 0xffff0000, v6
    v_lshlrev_b32 v154, 16, v7
    v_and_b32 v155, 0xffff0000, v7
    v_lshlrev_b32 v156, 16, v8
    v_and_b32 v157, 0xffff0000, v8
    v_lshlrev_b32 v158, 16, v9
    v_and_b32 v159, 0xffff0000, v9
    v_add_f32 v144, 1.0, v144
    v_add_f32 v145, 1.0, v145
    v_add_f32 v146, 1.0, v146
    v_add_f32 v147, 1.0, v147
    v_add_f32 v148, 1.0, v148
    v_add_f32 v149, 1.0, v149
    v_add_f32 v150, 1.0, v150
    v_add_f32 v151, 1.0, v151
    v_rcp_f32 v144, v144
    v_rcp_f32 v145, v145
    v_rcp_f32 v146, v146
    v_rcp_f32 v147, v147
    v_rcp_f32 v148, v148
    v_rcp_f32 v149, v149
    v_rcp_f32 v150, v150
    v_rcp_f32 v151, v151
    s_nop 0
    v_pk_mul_f32 v[136:137], v[136:137], v[144:145]
    v_pk_mul_f32 v[138:139], v[138:139], v[146:147]
    v_pk_mul_f32 v[140:141], v[140:141], v[148:149]
    v_pk_mul_f32 v[142:143], v[142:143], v[150:151]
    v_pk_fma_f32 v[136:137], v[120:121], v[136:137], v[152:153]
    v_pk_fma_f32 v[138:139], v[122:123], v[138:139], v[154:155]
    v_pk_fma_f32 v[140:141], v[124:125], v[140:141], v[156:157]
    v_pk_fma_f32 v[142:143], v[126:127], v[142:143], v[158:159]
    v_cvt_pk_bf16_f32 v160, v136, v137
    v_cvt_pk_bf16_f32 v161, v138, v139
    v_cvt_pk_bf16_f32 v162, v140, v141
    v_cvt_pk_bf16_f32 v163, v142, v143
    buffer_store_dwordx4 v[160:163], v5, s[60:63], s64 offen
    v_lshlrev_b32 v168, 16, v18
    v_and_b32 v169, 0xffff0000, v18
    v_lshlrev_b32 v170, 16, v19
    v_and_b32 v171, 0xffff0000, v19
    v_lshlrev_b32 v172, 16, v20
    v_and_b32 v173, 0xffff0000, v20
    v_lshlrev_b32 v174, 16, v21
    v_and_b32 v175, 0xffff0000, v21
    s_waitcnt lgkmcnt(8)
    v_pk_add_f32 v[72:73], v[72:73], v[80:81]
    v_pk_add_f32 v[168:169], v[168:169], v[88:89]
    v_pk_add_f32 v[74:75], v[74:75], v[82:83]
    v_pk_add_f32 v[170:171], v[170:171], v[90:91]
    v_pk_add_f32 v[76:77], v[76:77], v[84:85]
    v_pk_add_f32 v[172:173], v[172:173], v[92:93]
    v_pk_add_f32 v[78:79], v[78:79], v[86:87]
    v_pk_add_f32 v[174:175], v[174:175], v[94:95]
    v_pk_add_f32 v[168:169], v[168:169], v[72:73]
    v_pk_add_f32 v[170:171], v[170:171], v[74:75]
    v_pk_add_f32 v[172:173], v[172:173], v[76:77]
    v_pk_add_f32 v[174:175], v[174:175], v[78:79]
    v_mul_f32 v176, 0xbfb8aa3b, v168
    v_mul_f32 v177, 0xbfb8aa3b, v169
    v_mul_f32 v178, 0xbfb8aa3b, v170
    v_mul_f32 v179, 0xbfb8aa3b, v171
    v_mul_f32 v180, 0xbfb8aa3b, v172
    v_mul_f32 v181, 0xbfb8aa3b, v173
    v_mul_f32 v182, 0xbfb8aa3b, v174
    v_mul_f32 v183, 0xbfb8aa3b, v175
    v_exp_f32 v176, v176
    v_exp_f32 v177, v177
    v_exp_f32 v178, v178
    v_exp_f32 v179, v179
    v_exp_f32 v180, v180
    v_exp_f32 v181, v181
    v_exp_f32 v182, v182
    v_exp_f32 v183, v183
    v_lshlrev_b32 v184, 16, v10
    v_and_b32 v185, 0xffff0000, v10
    v_lshlrev_b32 v186, 16, v11
    v_and_b32 v187, 0xffff0000, v11
    v_lshlrev_b32 v188, 16, v12
    v_and_b32 v189, 0xffff0000, v12
    v_lshlrev_b32 v190, 16, v13
    v_and_b32 v191, 0xffff0000, v13
    v_add_f32 v176, 1.0, v176
    v_add_f32 v177, 1.0, v177
    v_add_f32 v178, 1.0, v178
    v_add_f32 v179, 1.0, v179
    v_add_f32 v180, 1.0, v180
    v_add_f32 v181, 1.0, v181
    v_add_f32 v182, 1.0, v182
    v_add_f32 v183, 1.0, v183
    v_rcp_f32 v176, v176
    v_rcp_f32 v177, v177
    v_rcp_f32 v178, v178
    v_rcp_f32 v179, v179
    v_rcp_f32 v180, v180
    v_rcp_f32 v181, v181
    v_rcp_f32 v182, v182
    v_rcp_f32 v183, v183
    s_waitcnt lgkmcnt(0)
    v_pk_mul_f32 v[168:169], v[168:169], v[176:177]
    v_pk_mul_f32 v[170:171], v[170:171], v[178:179]
    v_pk_mul_f32 v[172:173], v[172:173], v[180:181]
    v_pk_mul_f32 v[174:175], v[174:175], v[182:183]
    v_pk_fma_f32 v[168:169], v[128:129], v[168:169], v[184:185]
    v_pk_fma_f32 v[170:171], v[130:131], v[170:171], v[186:187]
    v_pk_fma_f32 v[172:173], v[132:133], v[172:173], v[188:189]
    v_pk_fma_f32 v[174:175], v[134:135], v[174:175], v[190:191]
    v_cvt_pk_bf16_f32 v192, v168, v169
    v_cvt_pk_bf16_f32 v193, v170, v171
    v_cvt_pk_bf16_f32 v194, v172, v173
    v_cvt_pk_bf16_f32 v195, v174, v175
    buffer_store_dwordx4 v[192:195], v5, s[60:63], s65 offen
K2_END:
    s_endpgm
CODE_END:
.section .rodata,"a"
.p2align 6
.amdhsa_kernel k1_kernel
  .amdhsa_next_free_vgpr 256
  .amdhsa_next_free_sgpr 102
  .amdhsa_accum_offset 256
  .amdhsa_group_segment_fixed_size 0
  .amdhsa_kernarg_size 104
  .amdhsa_user_sgpr_count 2
  .amdhsa_user_sgpr_kernarg_segment_ptr 1
  .amdhsa_system_sgpr_workgroup_id_x 1
.end_amdhsa_kernel
.p2align 6
.amdhsa_kernel k2_kernel
  .amdhsa_next_free_vgpr 448
  .amdhsa_next_free_sgpr 102
  .amdhsa_accum_offset 256
  .amdhsa_group_segment_fixed_size 0
  .amdhsa_kernarg_size 104
  .amdhsa_user_sgpr_count 2
  .amdhsa_user_sgpr_kernarg_segment_ptr 1
  .amdhsa_system_sgpr_workgroup_id_x 1
.end_amdhsa_kernel
```
